```python
import torch

def _softmax(x, axis=-1):
    return torch.softmax(x, dim=axis)
def _gelu(x):
    return torch.nn.functional.gelu(x, approximate="tanh")
def _silu(x):
    return torch.nn.functional.silu(x)
def _sigmoid(x):
    return torch.sigmoid(x)
def _layernorm(x, axis=-1, eps=1e-5):
    m = x.mean(dim=axis, keepdim=True)
    v = x.var(dim=axis, keepdim=True, unbiased=False)
    return (x - m) / torch.sqrt(v + eps)
def _scatter_add(tgt, idx, src, axis=0):
    return tgt.clone().index_add_(axis, idx, src)
def _segment_sum(src, seg, n):
    out = torch.zeros((n,) + src.shape[1:], dtype=src.dtype)
    return out.index_add_(0, seg, src)
def _pad(x, pw):
    flat = tuple(v for pair in reversed(pw) for v in pair)
    return torch.nn.functional.pad(x, flat)

kernel_name = 'standalone__paged_block_table_kv_pagedattention__sampling'

def setup_inputs():

    _w = (lambda a: (lambda t: t.to(torch.bfloat16) if t.is_floating_point() else t)(torch.as_tensor(a)))
    B, Hq, Hkv, Sq, Skv, D = 8, 32, 8, 32, 8192, 128
    bs = 16
    nbps = max(1, Skv // bs)
    num_phys = B * nbps + 4
    bt = torch.randperm(num_phys)[: B * nbps].reshape(B, nbps).to(torch.int64)
    cl = (nbps * bs - (torch.arange(1, B + 1, dtype=torch.int64) * 2654435761) % max(1, nbps * bs // 2)).to(torch.int64)
    return {
        "q": _w((lambda *s: torch.randn(*s, dtype=torch.bfloat16) * 0.8)(B, Hq, Sq, D)),
        "k_cache": _w((lambda *s: torch.randn(*s, dtype=torch.bfloat16) * 0.8)(num_phys, bs, Hkv, D)),
        "v_cache": _w((lambda *s: torch.randn(*s, dtype=torch.bfloat16) * 0.05)(num_phys, bs, Hkv, D)),
        "block_table": _w(bt),
        "context_lens": _w(cl),
    }

def reference(q, k_cache, v_cache, block_table, context_lens):
    B, Hq, Sq, D = q.shape
    bs = k_cache.shape[1]
    Hkv = k_cache.shape[2]
    nbps = block_table.shape[1]
    Skv = nbps * bs
    bt = block_table.reshape(-1)
    k = (lambda x, *d: x.permute(*d))(k_cache[bt].reshape(B, Skv, Hkv, D), 0, 2, 1, 3)
    v = (lambda x, *d: x.permute(*d))(v_cache[bt].reshape(B, Skv, Hkv, D), 0, 2, 1, 3)
    g = Hq // Hkv
    qg = q.reshape(B, Hkv, g, Sq, D)
    scores = torch.einsum("bhgqd,bhkd->bhgqk", qg, k) * (D ** -0.5)
    pos = torch.arange(Skv)
    msk = pos[None, :] < context_lens[:, None]
    scores = torch.where(msk[:, None, None, None, :], scores, -1e9)
    p = _softmax(scores, axis=-1)
    out = torch.einsum("bhgqk,bhkd->bhgqd", p, v)
    return out.reshape(B, Hq, Sq, D)
```

```asm
; @launch grid=(256,1,1) block=(512,1,1) lds=133120
.amdgcn_target "amdgcn-amd-amdhsa--gfx950"
.text
    .globl standalone__paged_block_table_kv_pagedattention__sampling_kernel
    .p2align 8
    .type standalone__paged_block_table_kv_pagedattention__sampling_kernel,@function
standalone__paged_block_table_kv_pagedattention__sampling_kernel:
    s_cmp_ge_u32 s2, 256
    s_cbranch_scc1 L_end
    s_load_dwordx16 s[16:31], s[0:1], 0
    s_and_b32 s4, s2, 7
    s_lshr_b32 s5, s2, 3
    s_mov_b32 s35, 4096
    v_lshrrev_b32 v248, 6, v0
    v_and_b32 v251, 63, v0
    v_readfirstlane_b32 s6, v248
    s_waitcnt lgkmcnt(0)
    s_lshr_b32 s3, s18, 8
    s_sub_u32 s4, s4, s3
    s_and_b32 s4, s4, 7
    s_load_dwordx8 s[56:63], s[24:25], 0
    s_cmp_ge_u32 s6, 4
    s_cbranch_scc1 L_loader
    s_mov_b32 s36, s16
    s_and_b32 s37, s17, 0xffff
    s_mov_b32 s38, 0x200000
    s_mov_b32 s39, 0x20000
    s_mov_b32 s48, s30
    s_and_b32 s49, s31, 0xffff
    s_mov_b32 s50, 0x2000000
    s_mov_b32 s51, 0x20000
    s_mov_b32 s40, s28
    s_and_b32 s41, s29, 0xffff
    s_mov_b32 s42, 0x100
    s_mov_b32 s43, 0x20000
    s_mov_b32 s64, s26
    s_and_b32 s65, s27, 0xffff
    s_mov_b32 s66, 0x200000
    s_mov_b32 s67, 0x20000
    s_lshl_b32 s91, s4, 5
    s_mul_i32 s97, s4, 44
    v_mov_b32 v254, 0
    s_or_b32 s3, s5, s6
    s_cbranch_scc1 L_noclr
    s_lshl_b32 s3, s97, 8
    s_add_u32 s3, s3, 14680064
    v_lshlrev_b32 v1, 6, v251
    v_add_u32 v2, 4096, v1
    v_add_u32 v3, 7168, v1
    buffer_store_dword v254, v1, s[48:51], s3 offen sc1
    buffer_store_dword v254, v2, s[48:51], s3 offen sc1
    buffer_store_dword v254, v3, s[48:51], s3 offen sc1
L_noclr:
    v_and_b32 v248, 15, v251
    v_lshrrev_b32 v249, 4, v251
    v_xor_b32 v250, v248, v249
    v_lshlrev_b32 v250, 4, v250
    v_lshl_add_u32 v228, v248, 8, v250
    v_xor_b32 v229, 64, v228
    v_xor_b32 v230, 128, v228
    v_xor_b32 v231, 192, v228
    v_lshrrev_b32 v248, 2, v251
    v_lshrrev_b32 v249, 5, v251
    v_lshlrev_b32 v249, 2, v249
    v_xor_b32 v249, v249, v248
    v_and_b32 v249, 7, v249
    v_lshlrev_b32 v250, 8, v248
    v_lshl_add_u32 v250, v249, 5, v250
    v_and_b32 v248, 3, v251
    v_lshl_add_u32 v250, v248, 3, v250
    v_add_u32 v232, 49152, v250
    v_xor_b32 v233, 32, v232
    v_xor_b32 v234, 64, v232
    v_xor_b32 v235, 96, v232
    v_xor_b32 v236, 128, v232
    v_xor_b32 v237, 160, v232
    v_xor_b32 v238, 192, v232
    v_xor_b32 v239, 224, v232
    s_mov_b32 s15, 0x44800000
    s_waitcnt lgkmcnt(0)
    s_mov_b32 s76, 0
    s_sub_u32 s68, 0, s56
    s_max_u32 s68, s68, 0xffffe000
    s_ashr_i32 s3, s68, 5
    s_sub_u32 s68, 0, s68
    s_sub_u32 s77, s76, s3
    s_sub_u32 s69, 0, s57
    s_max_u32 s69, s69, 0xffffe000
    s_ashr_i32 s3, s69, 5
    s_sub_u32 s69, 0, s69
    s_sub_u32 s78, s77, s3
    s_sub_u32 s70, 0, s58
    s_max_u32 s70, s70, 0xffffe000
    s_ashr_i32 s3, s70, 5
    s_sub_u32 s70, 0, s70
    s_sub_u32 s79, s78, s3
    s_sub_u32 s71, 0, s59
    s_max_u32 s71, s71, 0xffffe000
    s_ashr_i32 s3, s71, 5
    s_sub_u32 s71, 0, s71
    s_sub_u32 s80, s79, s3
    s_sub_u32 s72, 0, s60
    s_max_u32 s72, s72, 0xffffe000
    s_ashr_i32 s3, s72, 5
    s_sub_u32 s72, 0, s72
    s_sub_u32 s81, s80, s3
    s_sub_u32 s73, 0, s61
    s_max_u32 s73, s73, 0xffffe000
    s_ashr_i32 s3, s73, 5
    s_sub_u32 s73, 0, s73
    s_sub_u32 s82, s81, s3
    s_sub_u32 s74, 0, s62
    s_max_u32 s74, s74, 0xffffe000
    s_ashr_i32 s3, s74, 5
    s_sub_u32 s74, 0, s74
    s_sub_u32 s83, s82, s3
    s_sub_u32 s75, 0, s63
    s_max_u32 s75, s75, 0xffffe000
    s_ashr_i32 s3, s75, 5
    s_sub_u32 s75, 0, s75
    s_sub_u32 s84, s83, s3
    s_add_u32 s32, s84, 7
    s_mul_i32 s32, s32, s35
    s_mul_i32 s7, s5, s32
    s_add_u32 s8, s7, s32
    s_lshr_b32 s7, s7, 17
    s_lshr_b32 s8, s8, 17
    s_cmp_gt_u32 s7, s77
    s_subb_u32 s7, s7, 0
    s_cmp_gt_u32 s8, s77
    s_subb_u32 s8, s8, 0
    s_cmp_gt_u32 s7, s78
    s_subb_u32 s7, s7, 0
    s_cmp_gt_u32 s8, s78
    s_subb_u32 s8, s8, 0
    s_cmp_gt_u32 s7, s79
    s_subb_u32 s7, s7, 0
    s_cmp_gt_u32 s8, s79
    s_subb_u32 s8, s8, 0
    s_cmp_gt_u32 s7, s80
    s_subb_u32 s7, s7, 0
    s_cmp_gt_u32 s8, s80
    s_subb_u32 s8, s8, 0
    s_cmp_gt_u32 s7, s81
    s_subb_u32 s7, s7, 0
    s_cmp_gt_u32 s8, s81
    s_subb_u32 s8, s8, 0
    s_cmp_gt_u32 s7, s82
    s_subb_u32 s7, s7, 0
    s_cmp_gt_u32 s8, s82
    s_subb_u32 s8, s8, 0
    s_cmp_gt_u32 s7, s83
    s_subb_u32 s7, s7, 0
    s_cmp_gt_u32 s8, s83
    s_subb_u32 s8, s8, 0
    s_sub_u32 s8, s8, s7
    s_cmp_eq_u32 s8, 0
    s_cbranch_scc1 L_idle
    s_mov_b32 s14, 0
    s_cmp_le_u32 s77, s7
    s_cselect_b32 s14, 1, s14
    s_cmp_le_u32 s78, s7
    s_cselect_b32 s14, 2, s14
    s_cmp_le_u32 s79, s7
    s_cselect_b32 s14, 3, s14
    s_cmp_le_u32 s80, s7
    s_cselect_b32 s14, 4, s14
    s_cmp_le_u32 s81, s7
    s_cselect_b32 s14, 5, s14
    s_cmp_le_u32 s82, s7
    s_cselect_b32 s14, 6, s14
    s_cmp_le_u32 s83, s7
    s_cselect_b32 s14, 7, s14
    s_mov_b32 m0, s14
    s_nop 0
    s_movrels_b32 s12, s68
    s_movrels_b32 s11, s77
    s_movrels_b32 s13, s56
    s_sub_u32 s11, s11, s7
    s_min_u32 s10, s11, s8
    s_sub_u32 s11, s11, 1
    s_sub_u32 s12, s12, 1
    s_and_b32 s12, s12, 31
    s_add_u32 s12, s12, 1
    s_cmp_gt_i32 s13, 0
    s_cselect_b32 s13, 0x3e0293ee, 0
    s_add_u32 s32, s14, 0
    s_lshl_b32 s32, s32, 3
    s_add_u32 s32, s32, s4
    s_lshl_b32 s32, s32, 2
    s_add_u32 s32, s32, s6
    s_lshl_b32 s32, s32, 13
    v_and_b32 v248, 15, v251
    v_lshrrev_b32 v249, 4, v251
    v_lshlrev_b32 v248, 8, v248
    v_lshl_add_u32 v248, v249, 4, v248
    v_add_u32 v249, 4096, v248
    buffer_load_dwordx4 v[136:139], v248, s[36:39], s32 offen offset:0
    buffer_load_dwordx4 v[140:143], v248, s[36:39], s32 offen offset:64
    buffer_load_dwordx4 v[144:147], v248, s[36:39], s32 offen offset:128
    buffer_load_dwordx4 v[148:151], v248, s[36:39], s32 offen offset:192
    buffer_load_dwordx4 v[152:155], v249, s[36:39], s32 offen offset:0
    buffer_load_dwordx4 v[156:159], v249, s[36:39], s32 offen offset:64
    buffer_load_dwordx4 v[160:163], v249, s[36:39], s32 offen offset:128
    buffer_load_dwordx4 v[164:167], v249, s[36:39], s32 offen offset:192
    s_barrier
    s_add_u32 s32, s7, s8
    s_mov_b32 s86, 0
    s_mov_b32 s87, s77
    s_cmp_lt_u32 s77, s32
    s_cselect_b32 s86, s77, s86
    s_cselect_b32 s87, s78, s87
    s_cmp_lt_u32 s78, s32
    s_cselect_b32 s86, s78, s86
    s_cselect_b32 s87, s79, s87
    s_cmp_lt_u32 s79, s32
    s_cselect_b32 s86, s79, s86
    s_cselect_b32 s87, s80, s87
    s_cmp_lt_u32 s80, s32
    s_cselect_b32 s86, s80, s86
    s_cselect_b32 s87, s81, s87
    s_cmp_lt_u32 s81, s32
    s_cselect_b32 s86, s81, s86
    s_cselect_b32 s87, s82, s87
    s_cmp_lt_u32 s82, s32
    s_cselect_b32 s86, s82, s86
    s_cselect_b32 s87, s83, s87
    s_cmp_lt_u32 s83, s32
    s_cselect_b32 s86, s83, s86
    s_cselect_b32 s87, s84, s87
    s_add_u32 s32, s84, 7
    s_mul_i32 s32, s32, s35
    v_mul_lo_u32 v1, s32, v251
    v_add_u32 v2, s32, v1
    v_lshrrev_b32 v1, 17, v1
    v_lshrrev_b32 v2, 17, v2
    v_subrev_u32 v3, s77, v1
    v_med3_i32 v3, v3, 0, 1
    v_sub_u32 v1, v1, v3
    v_subrev_u32 v3, s77, v2
    v_med3_i32 v3, v3, 0, 1
    v_sub_u32 v2, v2, v3
    v_subrev_u32 v3, s78, v1
    v_med3_i32 v3, v3, 0, 1
    v_sub_u32 v1, v1, v3
    v_subrev_u32 v3, s78, v2
    v_med3_i32 v3, v3, 0, 1
    v_sub_u32 v2, v2, v3
    v_subrev_u32 v3, s79, v1
    v_med3_i32 v3, v3, 0, 1
    v_sub_u32 v1, v1, v3
    v_subrev_u32 v3, s79, v2
    v_med3_i32 v3, v3, 0, 1
    v_sub_u32 v2, v2, v3
    v_subrev_u32 v3, s80, v1
    v_med3_i32 v3, v3, 0, 1
    v_sub_u32 v1, v1, v3
    v_subrev_u32 v3, s80, v2
    v_med3_i32 v3, v3, 0, 1
    v_sub_u32 v2, v2, v3
    v_subrev_u32 v3, s81, v1
    v_med3_i32 v3, v3, 0, 1
    v_sub_u32 v1, v1, v3
    v_subrev_u32 v3, s81, v2
    v_med3_i32 v3, v3, 0, 1
    v_sub_u32 v2, v2, v3
    v_subrev_u32 v3, s82, v1
    v_med3_i32 v3, v3, 0, 1
    v_sub_u32 v1, v1, v3
    v_subrev_u32 v3, s82, v2
    v_med3_i32 v3, v3, 0, 1
    v_sub_u32 v2, v2, v3
    v_subrev_u32 v3, s83, v1
    v_med3_i32 v3, v3, 0, 1
    v_sub_u32 v1, v1, v3
    v_subrev_u32 v3, s83, v2
    v_med3_i32 v3, v3, 0, 1
    v_sub_u32 v2, v2, v3
    v_cmp_ge_u32 s[94:95], s87, v2
    v_max_u32 v1, s86, v1
    v_min_u32 v2, s87, v2
    v_cmp_lt_u32 vcc, v1, v2
    s_and_b32 s89, s5, 15
    s_add_u32 s89, s89, 3
    s_mov_b32 s90, -1
    s_mov_b64 s[86:87], vcc
    s_and_b64 s[94:95], s[94:95], vcc
    s_bcnt1_i32_b64 s32, s[94:95]
    s_bfm_b64 s[98:99], s5, 0
    s_and_b64 s[94:95], s[94:95], s[98:99]
    s_bcnt1_i32_b64 s33, s[94:95]
    s_mov_b32 s88, s6
    s_cmp_ge_u32 s88, s32
    s_cselect_b32 s3, s32, 0
    s_sub_u32 s88, s88, s3
    s_cmp_ge_u32 s88, s32
    s_cselect_b32 s3, s32, 0
    s_sub_u32 s88, s88, s3
    s_cmp_ge_u32 s88, s32
    s_cselect_b32 s3, s32, 0
    s_sub_u32 s88, s88, s3
    s_bitset0_b64 s[86:87], s5
    s_sub_u32 s88, s88, s33
    s_mov_b32 s9, 0
    s_mov_b32 s34, 15
    s_waitcnt vmcnt(0)
    s_or_b32 s3, s5, s6
    s_cbranch_scc1 L_nopuba
    v_mov_b32 v4, 1
    s_mov_b64 exec, 1
    s_waitcnt vmcnt(0)
    buffer_store_dword v4, off, s[40:43], s91 sc1
    s_mov_b64 exec, -1
L_nopuba:
    v_lshlrev_b32 v224, 16, v136
    v_and_b32 v225, 0xffff0000, v136
    v_mul_f32 v224, s13, v224
    v_mul_f32 v225, s13, v225
    v_cvt_pk_bf16_f32 v104, v224, v225
    v_lshlrev_b32 v226, 16, v137
    v_and_b32 v227, 0xffff0000, v137
    v_mul_f32 v226, s13, v226
    v_mul_f32 v227, s13, v227
    v_cvt_pk_bf16_f32 v105, v226, v227
    v_lshlrev_b32 v224, 16, v138
    v_and_b32 v225, 0xffff0000, v138
    v_mul_f32 v224, s13, v224
    v_mul_f32 v225, s13, v225
    v_cvt_pk_bf16_f32 v106, v224, v225
    v_lshlrev_b32 v226, 16, v139
    v_and_b32 v227, 0xffff0000, v139
    v_mul_f32 v226, s13, v226
    v_mul_f32 v227, s13, v227
    v_cvt_pk_bf16_f32 v107, v226, v227
    v_lshlrev_b32 v224, 16, v140
    v_and_b32 v225, 0xffff0000, v140
    v_mul_f32 v224, s13, v224
    v_mul_f32 v225, s13, v225
    v_cvt_pk_bf16_f32 v108, v224, v225
    v_lshlrev_b32 v226, 16, v141
    v_and_b32 v227, 0xffff0000, v141
    v_mul_f32 v226, s13, v226
    v_mul_f32 v227, s13, v227
    v_cvt_pk_bf16_f32 v109, v226, v227
    v_lshlrev_b32 v224, 16, v142
    v_and_b32 v225, 0xffff0000, v142
    v_mul_f32 v224, s13, v224
    v_mul_f32 v225, s13, v225
    v_cvt_pk_bf16_f32 v110, v224, v225
    v_lshlrev_b32 v226, 16, v143
    v_and_b32 v227, 0xffff0000, v143
    v_mul_f32 v226, s13, v226
    v_mul_f32 v227, s13, v227
    v_cvt_pk_bf16_f32 v111, v226, v227
    v_lshlrev_b32 v224, 16, v144
    v_and_b32 v225, 0xffff0000, v144
    v_mul_f32 v224, s13, v224
    v_mul_f32 v225, s13, v225
    v_cvt_pk_bf16_f32 v112, v224, v225
    v_lshlrev_b32 v226, 16, v145
    v_and_b32 v227, 0xffff0000, v145
    v_mul_f32 v226, s13, v226
    v_mul_f32 v227, s13, v227
    v_cvt_pk_bf16_f32 v113, v226, v227
    v_lshlrev_b32 v224, 16, v146
    v_and_b32 v225, 0xffff0000, v146
    v_mul_f32 v224, s13, v224
    v_mul_f32 v225, s13, v225
    v_cvt_pk_bf16_f32 v114, v224, v225
    v_lshlrev_b32 v226, 16, v147
    v_and_b32 v227, 0xffff0000, v147
    v_mul_f32 v226, s13, v226
    v_mul_f32 v227, s13, v227
    v_cvt_pk_bf16_f32 v115, v226, v227
    v_lshlrev_b32 v224, 16, v148
    v_and_b32 v225, 0xffff0000, v148
    v_mul_f32 v224, s13, v224
    v_mul_f32 v225, s13, v225
    v_cvt_pk_bf16_f32 v116, v224, v225
    v_lshlrev_b32 v226, 16, v149
    v_and_b32 v227, 0xffff0000, v149
    v_mul_f32 v226, s13, v226
    v_mul_f32 v227, s13, v227
    v_cvt_pk_bf16_f32 v117, v226, v227
    v_lshlrev_b32 v224, 16, v150
    v_and_b32 v225, 0xffff0000, v150
    v_mul_f32 v224, s13, v224
    v_mul_f32 v225, s13, v225
    v_cvt_pk_bf16_f32 v118, v224, v225
    v_lshlrev_b32 v226, 16, v151
    v_and_b32 v227, 0xffff0000, v151
    v_mul_f32 v226, s13, v226
    v_mul_f32 v227, s13, v227
    v_cvt_pk_bf16_f32 v119, v226, v227
    v_lshlrev_b32 v224, 16, v152
    v_and_b32 v225, 0xffff0000, v152
    v_mul_f32 v224, s13, v224
    v_mul_f32 v225, s13, v225
    v_cvt_pk_bf16_f32 v120, v224, v225
    v_lshlrev_b32 v226, 16, v153
    v_and_b32 v227, 0xffff0000, v153
    v_mul_f32 v226, s13, v226
    v_mul_f32 v227, s13, v227
    v_cvt_pk_bf16_f32 v121, v226, v227
    v_lshlrev_b32 v224, 16, v154
    v_and_b32 v225, 0xffff0000, v154
    v_mul_f32 v224, s13, v224
    v_mul_f32 v225, s13, v225
    v_cvt_pk_bf16_f32 v122, v224, v225
    v_lshlrev_b32 v226, 16, v155
    v_and_b32 v227, 0xffff0000, v155
    v_mul_f32 v226, s13, v226
    v_mul_f32 v227, s13, v227
    v_cvt_pk_bf16_f32 v123, v226, v227
    v_lshlrev_b32 v224, 16, v156
    v_and_b32 v225, 0xffff0000, v156
    v_mul_f32 v224, s13, v224
    v_mul_f32 v225, s13, v225
    v_cvt_pk_bf16_f32 v124, v224, v225
    v_lshlrev_b32 v226, 16, v157
    v_and_b32 v227, 0xffff0000, v157
    v_mul_f32 v226, s13, v226
    v_mul_f32 v227, s13, v227
    v_cvt_pk_bf16_f32 v125, v226, v227
    v_lshlrev_b32 v224, 16, v158
    v_and_b32 v225, 0xffff0000, v158
    v_mul_f32 v224, s13, v224
    v_mul_f32 v225, s13, v225
    v_cvt_pk_bf16_f32 v126, v224, v225
    v_lshlrev_b32 v226, 16, v159
    v_and_b32 v227, 0xffff0000, v159
    v_mul_f32 v226, s13, v226
    v_mul_f32 v227, s13, v227
    v_cvt_pk_bf16_f32 v127, v226, v227
    v_lshlrev_b32 v224, 16, v160
    v_and_b32 v225, 0xffff0000, v160
    v_mul_f32 v224, s13, v224
    v_mul_f32 v225, s13, v225
    v_cvt_pk_bf16_f32 v128, v224, v225
    v_lshlrev_b32 v226, 16, v161
    v_and_b32 v227, 0xffff0000, v161
    v_mul_f32 v226, s13, v226
    v_mul_f32 v227, s13, v227
    v_cvt_pk_bf16_f32 v129, v226, v227
    v_lshlrev_b32 v224, 16, v162
    v_and_b32 v225, 0xffff0000, v162
    v_mul_f32 v224, s13, v224
    v_mul_f32 v225, s13, v225
    v_cvt_pk_bf16_f32 v130, v224, v225
    v_lshlrev_b32 v226, 16, v163
    v_and_b32 v227, 0xffff0000, v163
    v_mul_f32 v226, s13, v226
    v_mul_f32 v227, s13, v227
    v_cvt_pk_bf16_f32 v131, v226, v227
    v_lshlrev_b32 v224, 16, v164
    v_and_b32 v225, 0xffff0000, v164
    v_mul_f32 v224, s13, v224
    v_mul_f32 v225, s13, v225
    v_cvt_pk_bf16_f32 v132, v224, v225
    v_lshlrev_b32 v226, 16, v165
    v_and_b32 v227, 0xffff0000, v165
    v_mul_f32 v226, s13, v226
    v_mul_f32 v227, s13, v227
    v_cvt_pk_bf16_f32 v133, v226, v227
    v_lshlrev_b32 v224, 16, v166
    v_and_b32 v225, 0xffff0000, v166
    v_mul_f32 v224, s13, v224
    v_mul_f32 v225, s13, v225
    v_cvt_pk_bf16_f32 v134, v224, v225
    v_lshlrev_b32 v226, 16, v167
    v_and_b32 v227, 0xffff0000, v167
    v_mul_f32 v226, s13, v226
    v_mul_f32 v227, s13, v227
    v_cvt_pk_bf16_f32 v135, v226, v227
    s_add_u32 s32, s14, 1
    s_lshl_b32 s32, s32, 3
    s_add_u32 s32, s32, s4
    s_lshl_b32 s32, s32, 2
    s_add_u32 s32, s32, s6
    s_lshl_b32 s32, s32, 13
    v_and_b32 v248, 15, v251
    v_lshrrev_b32 v249, 4, v251
    v_lshlrev_b32 v248, 8, v248
    v_lshl_add_u32 v248, v249, 4, v248
    v_add_u32 v249, 4096, v248
    s_cmp_lt_u32 s10, s8
    s_cselect_b32 s32, s32, 0x80000000
    buffer_load_dwordx4 v[136:139], v248, s[36:39], s32 offen offset:0
    buffer_load_dwordx4 v[140:143], v248, s[36:39], s32 offen offset:64
    buffer_load_dwordx4 v[144:147], v248, s[36:39], s32 offen offset:128
    buffer_load_dwordx4 v[148:151], v248, s[36:39], s32 offen offset:192
    buffer_load_dwordx4 v[152:155], v249, s[36:39], s32 offen offset:0
    buffer_load_dwordx4 v[156:159], v249, s[36:39], s32 offen offset:64
    buffer_load_dwordx4 v[160:163], v249, s[36:39], s32 offen offset:128
    buffer_load_dwordx4 v[164:167], v249, s[36:39], s32 offen offset:192
    s_barrier
    s_branch L_first
    .p2align 6
L_ph0:
    s_barrier
    s_cmp_ge_u32 s9, s10
    s_cbranch_scc1 L_bnd0
    ds_read_b128 v[168:171], v228 offset:0
    ds_read_b128 v[172:175], v229 offset:0
    ds_read_b128 v[176:179], v230 offset:0
    ds_read_b128 v[180:183], v231 offset:0
    v_exp_f32 v224, v84
    v_exp_f32 v225, v85
    v_exp_f32 v226, v86
    v_exp_f32 v227, v87
    v_cvt_pk_bf16_f32 v220, v224, v225
    s_waitcnt lgkmcnt(3)
    v_mfma_f32_16x16x32_bf16 v[64:67], v[168:171], v[104:107], v[96:99]
    v_mfma_f32_16x16x32_bf16 v[68:71], v[168:171], v[120:123], v[100:103]
    ds_read_b128 v[168:171], v228 offset:4096
    v_pk_add_f32 v[246:247], v[224:225], v[226:227]
    s_waitcnt lgkmcnt(3)
    v_mfma_f32_16x16x32_bf16 v[64:67], v[172:175], v[108:111], v[64:67]
    v_cvt_pk_bf16_f32 v221, v226, v227
    v_mfma_f32_16x16x32_bf16 v[68:71], v[172:175], v[124:127], v[68:71]
    ds_read_b128 v[172:175], v229 offset:4096
    ds_read_b64_tr_b16 v[184:185], v232 offset:40960
    v_exp_f32 v224, v92
    s_waitcnt lgkmcnt(4)
    v_mfma_f32_16x16x32_bf16 v[64:67], v[176:179], v[112:115], v[64:67]
    ds_read_b64_tr_b16 v[186:187], v232 offset:45056
    v_exp_f32 v225, v93
    v_mfma_f32_16x16x32_bf16 v[68:71], v[176:179], v[128:131], v[68:71]
    ds_read_b128 v[176:179], v230 offset:4096
    ds_read_b64_tr_b16 v[188:189], v233 offset:40960
    v_exp_f32 v226, v94
    s_waitcnt lgkmcnt(6)
    v_mfma_f32_16x16x32_bf16 v[64:67], v[180:183], v[116:119], v[64:67]
    ds_read_b64_tr_b16 v[190:191], v233 offset:45056
    v_pk_add_f32 v[246:247], v[246:247], v[224:225]
    v_mfma_f32_16x16x32_bf16 v[68:71], v[180:183], v[132:135], v[68:71]
    ds_read_b128 v[180:183], v231 offset:4096
    ds_read_b64_tr_b16 v[192:193], v234 offset:40960
    v_exp_f32 v227, v95
    s_waitcnt lgkmcnt(8)
    v_mfma_f32_16x16x32_bf16 v[72:75], v[168:171], v[104:107], v[96:99]
    ds_read_b64_tr_b16 v[194:195], v234 offset:45056
    v_cvt_pk_bf16_f32 v222, v224, v225
    v_mfma_f32_16x16x32_bf16 v[76:79], v[168:171], v[120:123], v[100:103]
    ds_read_b64_tr_b16 v[196:197], v235 offset:40960
    v_pk_add_f32 v[246:247], v[246:247], v[226:227]
    s_waitcnt lgkmcnt(9)
    v_mfma_f32_16x16x32_bf16 v[72:75], v[172:175], v[108:111], v[72:75]
    ds_read_b64_tr_b16 v[198:199], v235 offset:45056
    v_cvt_pk_bf16_f32 v223, v226, v227
    v_mfma_f32_16x16x32_bf16 v[76:79], v[172:175], v[124:127], v[76:79]
    ds_read_b64_tr_b16 v[200:201], v236 offset:40960
    v_max3_f32 v248, v244, v245, v246
    s_waitcnt lgkmcnt(8)
    v_mfma_f32_16x16x32_bf16 v[72:75], v[176:179], v[112:115], v[72:75]
    ds_read_b64_tr_b16 v[202:203], v236 offset:45056
    v_max_f32 v248, v248, v247
    v_mfma_f32_16x16x32_bf16 v[76:79], v[176:179], v[128:131], v[76:79]
    ds_read_b64_tr_b16 v[204:205], v237 offset:40960
    v_cmp_lt_f32 vcc, s15, v248
    s_waitcnt lgkmcnt(7)
    v_mfma_f32_16x16x32_bf16 v[72:75], v[180:183], v[116:119], v[72:75]
    ds_read_b64_tr_b16 v[206:207], v237 offset:45056
    v_mfma_f32_16x16x32_bf16 v[76:79], v[180:183], v[132:135], v[76:79]
    ds_read_b64_tr_b16 v[208:209], v238 offset:40960
    s_cbranch_vccnz L_slow0
L_slow0_ret:
    v_mfma_f32_16x16x32_bf16 v[0:3], v[184:187], v[216:219], v[0:3]
    ds_read_b64_tr_b16 v[210:211], v238 offset:45056
    v_pk_add_f32 v[240:241], v[240:241], v[244:245]
    s_cmp_eq_u32 s9, s11
    v_mfma_f32_16x16x32_bf16 v[8:11], v[188:191], v[216:219], v[8:11]
    ds_read_b64_tr_b16 v[212:213], v239 offset:40960
    v_pk_add_f32 v[242:243], v[242:243], v[246:247]
    s_cbranch_scc1 L_mask0
L_mask0_ret:
    s_waitcnt lgkmcnt(9)
    v_mfma_f32_16x16x32_bf16 v[16:19], v[192:195], v[216:219], v[16:19]
    ds_read_b64_tr_b16 v[214:215], v239 offset:45056
    v_exp_f32 v224, v64
    s_waitcnt lgkmcnt(8)
    v_mfma_f32_16x16x32_bf16 v[24:27], v[196:199], v[216:219], v[24:27]
    v_exp_f32 v225, v65
    s_waitcnt lgkmcnt(6)
    v_mfma_f32_16x16x32_bf16 v[32:35], v[200:203], v[216:219], v[32:35]
    v_exp_f32 v226, v66
    s_waitcnt lgkmcnt(4)
    v_mfma_f32_16x16x32_bf16 v[40:43], v[204:207], v[216:219], v[40:43]
    v_exp_f32 v227, v67
    s_waitcnt lgkmcnt(2)
    v_mfma_f32_16x16x32_bf16 v[48:51], v[208:211], v[216:219], v[48:51]
    v_pk_add_f32 v[244:245], v[224:225], v[226:227]
    s_waitcnt lgkmcnt(0)
    v_mfma_f32_16x16x32_bf16 v[56:59], v[212:215], v[216:219], v[56:59]
    v_mfma_f32_16x16x32_bf16 v[4:7], v[184:187], v[220:223], v[4:7]
    v_cvt_pk_bf16_f32 v216, v224, v225
    v_cvt_pk_bf16_f32 v217, v226, v227
    v_exp_f32 v224, v72
    v_mfma_f32_16x16x32_bf16 v[12:15], v[188:191], v[220:223], v[12:15]
    v_exp_f32 v225, v73
    s_cmp_ge_i32 s9, s89
    s_cbranch_scc1 L_tick0
L_tick0_ret:
    v_mfma_f32_16x16x32_bf16 v[20:23], v[192:195], v[220:223], v[20:23]
    v_exp_f32 v226, v74
    v_mfma_f32_16x16x32_bf16 v[28:31], v[196:199], v[220:223], v[28:31]
    v_pk_add_f32 v[244:245], v[244:245], v[224:225]
    v_exp_f32 v227, v75
    v_mfma_f32_16x16x32_bf16 v[36:39], v[200:203], v[220:223], v[36:39]
    v_cvt_pk_bf16_f32 v218, v224, v225
    v_mfma_f32_16x16x32_bf16 v[44:47], v[204:207], v[220:223], v[44:47]
    v_pk_add_f32 v[244:245], v[244:245], v[226:227]
    v_mfma_f32_16x16x32_bf16 v[52:55], v[208:211], v[220:223], v[52:55]
    v_cvt_pk_bf16_f32 v219, v226, v227
    s_add_u32 s9, s9, 1
    v_mfma_f32_16x16x32_bf16 v[60:63], v[212:215], v[220:223], v[60:63]
L_ph1:
    s_barrier
    s_cmp_ge_u32 s9, s10
    s_cbranch_scc1 L_bnd1
    ds_read_b128 v[168:171], v228 offset:8192
    ds_read_b128 v[172:175], v229 offset:8192
    ds_read_b128 v[176:179], v230 offset:8192
    ds_read_b128 v[180:183], v231 offset:8192
    v_exp_f32 v224, v68
    v_exp_f32 v225, v69
    v_exp_f32 v226, v70
    v_exp_f32 v227, v71
    v_cvt_pk_bf16_f32 v220, v224, v225
    s_waitcnt lgkmcnt(3)
    v_mfma_f32_16x16x32_bf16 v[80:83], v[168:171], v[104:107], v[96:99]
    v_mfma_f32_16x16x32_bf16 v[84:87], v[168:171], v[120:123], v[100:103]
    ds_read_b128 v[168:171], v228 offset:12288
    v_pk_add_f32 v[246:247], v[224:225], v[226:227]
    s_waitcnt lgkmcnt(3)
    v_mfma_f32_16x16x32_bf16 v[80:83], v[172:175], v[108:111], v[80:83]
    v_cvt_pk_bf16_f32 v221, v226, v227
    v_mfma_f32_16x16x32_bf16 v[84:87], v[172:175], v[124:127], v[84:87]
    ds_read_b128 v[172:175], v229 offset:12288
    ds_read_b64_tr_b16 v[184:185], v232 offset:0
    v_exp_f32 v224, v76
    s_waitcnt lgkmcnt(4)
    v_mfma_f32_16x16x32_bf16 v[80:83], v[176:179], v[112:115], v[80:83]
    ds_read_b64_tr_b16 v[186:187], v232 offset:4096
    v_exp_f32 v225, v77
    v_mfma_f32_16x16x32_bf16 v[84:87], v[176:179], v[128:131], v[84:87]
    ds_read_b128 v[176:179], v230 offset:12288
    ds_read_b64_tr_b16 v[188:189], v233 offset:0
    v_exp_f32 v226, v78
    s_waitcnt lgkmcnt(6)
    v_mfma_f32_16x16x32_bf16 v[80:83], v[180:183], v[116:119], v[80:83]
    ds_read_b64_tr_b16 v[190:191], v233 offset:4096
    v_pk_add_f32 v[246:247], v[246:247], v[224:225]
    v_mfma_f32_16x16x32_bf16 v[84:87], v[180:183], v[132:135], v[84:87]
    ds_read_b128 v[180:183], v231 offset:12288
    ds_read_b64_tr_b16 v[192:193], v234 offset:0
    v_exp_f32 v227, v79
    s_waitcnt lgkmcnt(8)
    v_mfma_f32_16x16x32_bf16 v[88:91], v[168:171], v[104:107], v[96:99]
    ds_read_b64_tr_b16 v[194:195], v234 offset:4096
    v_cvt_pk_bf16_f32 v222, v224, v225
    v_mfma_f32_16x16x32_bf16 v[92:95], v[168:171], v[120:123], v[100:103]
    ds_read_b64_tr_b16 v[196:197], v235 offset:0
    v_pk_add_f32 v[246:247], v[246:247], v[226:227]
    s_waitcnt lgkmcnt(9)
    v_mfma_f32_16x16x32_bf16 v[88:91], v[172:175], v[108:111], v[88:91]
    ds_read_b64_tr_b16 v[198:199], v235 offset:4096
    v_cvt_pk_bf16_f32 v223, v226, v227
    v_mfma_f32_16x16x32_bf16 v[92:95], v[172:175], v[124:127], v[92:95]
    ds_read_b64_tr_b16 v[200:201], v236 offset:0
    v_max3_f32 v248, v244, v245, v246
    s_waitcnt lgkmcnt(8)
    v_mfma_f32_16x16x32_bf16 v[88:91], v[176:179], v[112:115], v[88:91]
    ds_read_b64_tr_b16 v[202:203], v236 offset:4096
    v_max_f32 v248, v248, v247
    v_mfma_f32_16x16x32_bf16 v[92:95], v[176:179], v[128:131], v[92:95]
    ds_read_b64_tr_b16 v[204:205], v237 offset:0
    v_cmp_lt_f32 vcc, s15, v248
    s_waitcnt lgkmcnt(7)
    v_mfma_f32_16x16x32_bf16 v[88:91], v[180:183], v[116:119], v[88:91]
    ds_read_b64_tr_b16 v[206:207], v237 offset:4096
    v_mfma_f32_16x16x32_bf16 v[92:95], v[180:183], v[132:135], v[92:95]
    ds_read_b64_tr_b16 v[208:209], v238 offset:0
    s_cbranch_vccnz L_slow1
L_slow1_ret:
    v_mfma_f32_16x16x32_bf16 v[0:3], v[184:187], v[216:219], v[0:3]
    ds_read_b64_tr_b16 v[210:211], v238 offset:4096
    v_pk_add_f32 v[240:241], v[240:241], v[244:245]
    s_cmp_eq_u32 s9, s11
    v_mfma_f32_16x16x32_bf16 v[8:11], v[188:191], v[216:219], v[8:11]
    ds_read_b64_tr_b16 v[212:213], v239 offset:0
    v_pk_add_f32 v[242:243], v[242:243], v[246:247]
    s_cbranch_scc1 L_mask1
L_mask1_ret:
    s_waitcnt lgkmcnt(9)
    v_mfma_f32_16x16x32_bf16 v[16:19], v[192:195], v[216:219], v[16:19]
    ds_read_b64_tr_b16 v[214:215], v239 offset:4096
    v_exp_f32 v224, v80
    s_waitcnt lgkmcnt(8)
    v_mfma_f32_16x16x32_bf16 v[24:27], v[196:199], v[216:219], v[24:27]
    v_exp_f32 v225, v81
    s_waitcnt lgkmcnt(6)
    v_mfma_f32_16x16x32_bf16 v[32:35], v[200:203], v[216:219], v[32:35]
    v_exp_f32 v226, v82
    s_waitcnt lgkmcnt(4)
    v_mfma_f32_16x16x32_bf16 v[40:43], v[204:207], v[216:219], v[40:43]
    v_exp_f32 v227, v83
    s_waitcnt lgkmcnt(2)
    v_mfma_f32_16x16x32_bf16 v[48:51], v[208:211], v[216:219], v[48:51]
    v_pk_add_f32 v[244:245], v[224:225], v[226:227]
    s_waitcnt lgkmcnt(0)
    v_mfma_f32_16x16x32_bf16 v[56:59], v[212:215], v[216:219], v[56:59]
    v_mfma_f32_16x16x32_bf16 v[4:7], v[184:187], v[220:223], v[4:7]
    v_cvt_pk_bf16_f32 v216, v224, v225
    v_cvt_pk_bf16_f32 v217, v226, v227
    v_exp_f32 v224, v88
    v_mfma_f32_16x16x32_bf16 v[12:15], v[188:191], v[220:223], v[12:15]
    v_exp_f32 v225, v89
    s_cmp_ge_i32 s9, s89
    s_cbranch_scc1 L_tick1
L_tick1_ret:
    v_mfma_f32_16x16x32_bf16 v[20:23], v[192:195], v[220:223], v[20:23]
    v_exp_f32 v226, v90
    v_mfma_f32_16x16x32_bf16 v[28:31], v[196:199], v[220:223], v[28:31]
    v_pk_add_f32 v[244:245], v[244:245], v[224:225]
    v_exp_f32 v227, v91
    v_mfma_f32_16x16x32_bf16 v[36:39], v[200:203], v[220:223], v[36:39]
    v_cvt_pk_bf16_f32 v218, v224, v225
    v_mfma_f32_16x16x32_bf16 v[44:47], v[204:207], v[220:223], v[44:47]
    v_pk_add_f32 v[244:245], v[244:245], v[226:227]
    v_mfma_f32_16x16x32_bf16 v[52:55], v[208:211], v[220:223], v[52:55]
    v_cvt_pk_bf16_f32 v219, v226, v227
    s_add_u32 s9, s9, 1
    v_mfma_f32_16x16x32_bf16 v[60:63], v[212:215], v[220:223], v[60:63]
L_ph2:
    s_barrier
    s_cmp_ge_u32 s9, s10
    s_cbranch_scc1 L_bnd2
    ds_read_b128 v[168:171], v228 offset:16384
    ds_read_b128 v[172:175], v229 offset:16384
    ds_read_b128 v[176:179], v230 offset:16384
    ds_read_b128 v[180:183], v231 offset:16384
    v_exp_f32 v224, v84
    v_exp_f32 v225, v85
    v_exp_f32 v226, v86
    v_exp_f32 v227, v87
    v_cvt_pk_bf16_f32 v220, v224, v225
    s_waitcnt lgkmcnt(3)
    v_mfma_f32_16x16x32_bf16 v[64:67], v[168:171], v[104:107], v[96:99]
    v_mfma_f32_16x16x32_bf16 v[68:71], v[168:171], v[120:123], v[100:103]
    ds_read_b128 v[168:171], v228 offset:20480
    v_pk_add_f32 v[246:247], v[224:225], v[226:227]
    s_waitcnt lgkmcnt(3)
    v_mfma_f32_16x16x32_bf16 v[64:67], v[172:175], v[108:111], v[64:67]
    v_cvt_pk_bf16_f32 v221, v226, v227
    v_mfma_f32_16x16x32_bf16 v[68:71], v[172:175], v[124:127], v[68:71]
    ds_read_b128 v[172:175], v229 offset:20480
    ds_read_b64_tr_b16 v[184:185], v232 offset:8192
    v_exp_f32 v224, v92
    s_waitcnt lgkmcnt(4)
    v_mfma_f32_16x16x32_bf16 v[64:67], v[176:179], v[112:115], v[64:67]
    ds_read_b64_tr_b16 v[186:187], v232 offset:12288
    v_exp_f32 v225, v93
    v_mfma_f32_16x16x32_bf16 v[68:71], v[176:179], v[128:131], v[68:71]
    ds_read_b128 v[176:179], v230 offset:20480
    ds_read_b64_tr_b16 v[188:189], v233 offset:8192
    v_exp_f32 v226, v94
    s_waitcnt lgkmcnt(6)
    v_mfma_f32_16x16x32_bf16 v[64:67], v[180:183], v[116:119], v[64:67]
    ds_read_b64_tr_b16 v[190:191], v233 offset:12288
    v_pk_add_f32 v[246:247], v[246:247], v[224:225]
    v_mfma_f32_16x16x32_bf16 v[68:71], v[180:183], v[132:135], v[68:71]
    ds_read_b128 v[180:183], v231 offset:20480
    ds_read_b64_tr_b16 v[192:193], v234 offset:8192
    v_exp_f32 v227, v95
    s_waitcnt lgkmcnt(8)
    v_mfma_f32_16x16x32_bf16 v[72:75], v[168:171], v[104:107], v[96:99]
    ds_read_b64_tr_b16 v[194:195], v234 offset:12288
    v_cvt_pk_bf16_f32 v222, v224, v225
    v_mfma_f32_16x16x32_bf16 v[76:79], v[168:171], v[120:123], v[100:103]
    ds_read_b64_tr_b16 v[196:197], v235 offset:8192
    v_pk_add_f32 v[246:247], v[246:247], v[226:227]
    s_waitcnt lgkmcnt(9)
    v_mfma_f32_16x16x32_bf16 v[72:75], v[172:175], v[108:111], v[72:75]
    ds_read_b64_tr_b16 v[198:199], v235 offset:12288
    v_cvt_pk_bf16_f32 v223, v226, v227
    v_mfma_f32_16x16x32_bf16 v[76:79], v[172:175], v[124:127], v[76:79]
    ds_read_b64_tr_b16 v[200:201], v236 offset:8192
    v_max3_f32 v248, v244, v245, v246
    s_waitcnt lgkmcnt(8)
    v_mfma_f32_16x16x32_bf16 v[72:75], v[176:179], v[112:115], v[72:75]
    ds_read_b64_tr_b16 v[202:203], v236 offset:12288
    v_max_f32 v248, v248, v247
    v_mfma_f32_16x16x32_bf16 v[76:79], v[176:179], v[128:131], v[76:79]
    ds_read_b64_tr_b16 v[204:205], v237 offset:8192
    v_cmp_lt_f32 vcc, s15, v248
    s_waitcnt lgkmcnt(7)
    v_mfma_f32_16x16x32_bf16 v[72:75], v[180:183], v[116:119], v[72:75]
    ds_read_b64_tr_b16 v[206:207], v237 offset:12288
    v_mfma_f32_16x16x32_bf16 v[76:79], v[180:183], v[132:135], v[76:79]
    ds_read_b64_tr_b16 v[208:209], v238 offset:8192
    s_cbranch_vccnz L_slow2
L_slow2_ret:
    v_mfma_f32_16x16x32_bf16 v[0:3], v[184:187], v[216:219], v[0:3]
    ds_read_b64_tr_b16 v[210:211], v238 offset:12288
    v_pk_add_f32 v[240:241], v[240:241], v[244:245]
    s_cmp_eq_u32 s9, s11
    v_mfma_f32_16x16x32_bf16 v[8:11], v[188:191], v[216:219], v[8:11]
    ds_read_b64_tr_b16 v[212:213], v239 offset:8192
    v_pk_add_f32 v[242:243], v[242:243], v[246:247]
    s_cbranch_scc1 L_mask2
L_mask2_ret:
    s_waitcnt lgkmcnt(9)
    v_mfma_f32_16x16x32_bf16 v[16:19], v[192:195], v[216:219], v[16:19]
    ds_read_b64_tr_b16 v[214:215], v239 offset:12288
    v_exp_f32 v224, v64
    s_waitcnt lgkmcnt(8)
    v_mfma_f32_16x16x32_bf16 v[24:27], v[196:199], v[216:219], v[24:27]
    v_exp_f32 v225, v65
    s_waitcnt lgkmcnt(6)
    v_mfma_f32_16x16x32_bf16 v[32:35], v[200:203], v[216:219], v[32:35]
    v_exp_f32 v226, v66
    s_waitcnt lgkmcnt(4)
    v_mfma_f32_16x16x32_bf16 v[40:43], v[204:207], v[216:219], v[40:43]
    v_exp_f32 v227, v67
    s_waitcnt lgkmcnt(2)
    v_mfma_f32_16x16x32_bf16 v[48:51], v[208:211], v[216:219], v[48:51]
    v_pk_add_f32 v[244:245], v[224:225], v[226:227]
    s_waitcnt lgkmcnt(0)
    v_mfma_f32_16x16x32_bf16 v[56:59], v[212:215], v[216:219], v[56:59]
    v_mfma_f32_16x16x32_bf16 v[4:7], v[184:187], v[220:223], v[4:7]
    v_cvt_pk_bf16_f32 v216, v224, v225
    v_cvt_pk_bf16_f32 v217, v226, v227
    v_exp_f32 v224, v72
    v_mfma_f32_16x16x32_bf16 v[12:15], v[188:191], v[220:223], v[12:15]
    v_exp_f32 v225, v73
    s_cmp_ge_i32 s9, s89
    s_cbranch_scc1 L_tick2
L_tick2_ret:
    v_mfma_f32_16x16x32_bf16 v[20:23], v[192:195], v[220:223], v[20:23]
    v_exp_f32 v226, v74
    v_mfma_f32_16x16x32_bf16 v[28:31], v[196:199], v[220:223], v[28:31]
    v_pk_add_f32 v[244:245], v[244:245], v[224:225]
    v_exp_f32 v227, v75
    v_mfma_f32_16x16x32_bf16 v[36:39], v[200:203], v[220:223], v[36:39]
    v_cvt_pk_bf16_f32 v218, v224, v225
    v_mfma_f32_16x16x32_bf16 v[44:47], v[204:207], v[220:223], v[44:47]
    v_pk_add_f32 v[244:245], v[244:245], v[226:227]
    v_mfma_f32_16x16x32_bf16 v[52:55], v[208:211], v[220:223], v[52:55]
    v_cvt_pk_bf16_f32 v219, v226, v227
    s_add_u32 s9, s9, 1
    v_mfma_f32_16x16x32_bf16 v[60:63], v[212:215], v[220:223], v[60:63]
L_ph3:
    s_barrier
    s_cmp_ge_u32 s9, s10
    s_cbranch_scc1 L_bnd3
    ds_read_b128 v[168:171], v228 offset:24576
    ds_read_b128 v[172:175], v229 offset:24576
    ds_read_b128 v[176:179], v230 offset:24576
    ds_read_b128 v[180:183], v231 offset:24576
    v_exp_f32 v224, v68
    v_exp_f32 v225, v69
    v_exp_f32 v226, v70
    v_exp_f32 v227, v71
    v_cvt_pk_bf16_f32 v220, v224, v225
    s_waitcnt lgkmcnt(3)
    v_mfma_f32_16x16x32_bf16 v[80:83], v[168:171], v[104:107], v[96:99]
    v_mfma_f32_16x16x32_bf16 v[84:87], v[168:171], v[120:123], v[100:103]
    ds_read_b128 v[168:171], v228 offset:28672
    v_pk_add_f32 v[246:247], v[224:225], v[226:227]
    s_waitcnt lgkmcnt(3)
    v_mfma_f32_16x16x32_bf16 v[80:83], v[172:175], v[108:111], v[80:83]
    v_cvt_pk_bf16_f32 v221, v226, v227
    v_mfma_f32_16x16x32_bf16 v[84:87], v[172:175], v[124:127], v[84:87]
    ds_read_b128 v[172:175], v229 offset:28672
    ds_read_b64_tr_b16 v[184:185], v232 offset:16384
    v_exp_f32 v224, v76
    s_waitcnt lgkmcnt(4)
    v_mfma_f32_16x16x32_bf16 v[80:83], v[176:179], v[112:115], v[80:83]
    ds_read_b64_tr_b16 v[186:187], v232 offset:20480
    v_exp_f32 v225, v77
    v_mfma_f32_16x16x32_bf16 v[84:87], v[176:179], v[128:131], v[84:87]
    ds_read_b128 v[176:179], v230 offset:28672
    ds_read_b64_tr_b16 v[188:189], v233 offset:16384
    v_exp_f32 v226, v78
    s_waitcnt lgkmcnt(6)
    v_mfma_f32_16x16x32_bf16 v[80:83], v[180:183], v[116:119], v[80:83]
    ds_read_b64_tr_b16 v[190:191], v233 offset:20480
    v_pk_add_f32 v[246:247], v[246:247], v[224:225]
    v_mfma_f32_16x16x32_bf16 v[84:87], v[180:183], v[132:135], v[84:87]
    ds_read_b128 v[180:183], v231 offset:28672
    ds_read_b64_tr_b16 v[192:193], v234 offset:16384
    v_exp_f32 v227, v79
    s_waitcnt lgkmcnt(8)
    v_mfma_f32_16x16x32_bf16 v[88:91], v[168:171], v[104:107], v[96:99]
    ds_read_b64_tr_b16 v[194:195], v234 offset:20480
    v_cvt_pk_bf16_f32 v222, v224, v225
    v_mfma_f32_16x16x32_bf16 v[92:95], v[168:171], v[120:123], v[100:103]
    ds_read_b64_tr_b16 v[196:197], v235 offset:16384
    v_pk_add_f32 v[246:247], v[246:247], v[226:227]
    s_waitcnt lgkmcnt(9)
    v_mfma_f32_16x16x32_bf16 v[88:91], v[172:175], v[108:111], v[88:91]
    ds_read_b64_tr_b16 v[198:199], v235 offset:20480
    v_cvt_pk_bf16_f32 v223, v226, v227
    v_mfma_f32_16x16x32_bf16 v[92:95], v[172:175], v[124:127], v[92:95]
    ds_read_b64_tr_b16 v[200:201], v236 offset:16384
    v_max3_f32 v248, v244, v245, v246
    s_waitcnt lgkmcnt(8)
    v_mfma_f32_16x16x32_bf16 v[88:91], v[176:179], v[112:115], v[88:91]
    ds_read_b64_tr_b16 v[202:203], v236 offset:20480
    v_max_f32 v248, v248, v247
    v_mfma_f32_16x16x32_bf16 v[92:95], v[176:179], v[128:131], v[92:95]
    ds_read_b64_tr_b16 v[204:205], v237 offset:16384
    v_cmp_lt_f32 vcc, s15, v248
    s_waitcnt lgkmcnt(7)
    v_mfma_f32_16x16x32_bf16 v[88:91], v[180:183], v[116:119], v[88:91]
    ds_read_b64_tr_b16 v[206:207], v237 offset:20480
    v_mfma_f32_16x16x32_bf16 v[92:95], v[180:183], v[132:135], v[92:95]
    ds_read_b64_tr_b16 v[208:209], v238 offset:16384
    s_cbranch_vccnz L_slow3
L_slow3_ret:
    v_mfma_f32_16x16x32_bf16 v[0:3], v[184:187], v[216:219], v[0:3]
    ds_read_b64_tr_b16 v[210:211], v238 offset:20480
    v_pk_add_f32 v[240:241], v[240:241], v[244:245]
    s_cmp_eq_u32 s9, s11
    v_mfma_f32_16x16x32_bf16 v[8:11], v[188:191], v[216:219], v[8:11]
    ds_read_b64_tr_b16 v[212:213], v239 offset:16384
    v_pk_add_f32 v[242:243], v[242:243], v[246:247]
    s_cbranch_scc1 L_mask3
L_mask3_ret:
    s_waitcnt lgkmcnt(9)
    v_mfma_f32_16x16x32_bf16 v[16:19], v[192:195], v[216:219], v[16:19]
    ds_read_b64_tr_b16 v[214:215], v239 offset:20480
    v_exp_f32 v224, v80
    s_waitcnt lgkmcnt(8)
    v_mfma_f32_16x16x32_bf16 v[24:27], v[196:199], v[216:219], v[24:27]
    v_exp_f32 v225, v81
    s_waitcnt lgkmcnt(6)
    v_mfma_f32_16x16x32_bf16 v[32:35], v[200:203], v[216:219], v[32:35]
    v_exp_f32 v226, v82
    s_waitcnt lgkmcnt(4)
    v_mfma_f32_16x16x32_bf16 v[40:43], v[204:207], v[216:219], v[40:43]
    v_exp_f32 v227, v83
    s_waitcnt lgkmcnt(2)
    v_mfma_f32_16x16x32_bf16 v[48:51], v[208:211], v[216:219], v[48:51]
    v_pk_add_f32 v[244:245], v[224:225], v[226:227]
    s_waitcnt lgkmcnt(0)
    v_mfma_f32_16x16x32_bf16 v[56:59], v[212:215], v[216:219], v[56:59]
    v_mfma_f32_16x16x32_bf16 v[4:7], v[184:187], v[220:223], v[4:7]
    v_cvt_pk_bf16_f32 v216, v224, v225
    v_cvt_pk_bf16_f32 v217, v226, v227
    v_exp_f32 v224, v88
    v_mfma_f32_16x16x32_bf16 v[12:15], v[188:191], v[220:223], v[12:15]
    v_exp_f32 v225, v89
    s_cmp_ge_i32 s9, s89
    s_cbranch_scc1 L_tick3
L_tick3_ret:
    v_mfma_f32_16x16x32_bf16 v[20:23], v[192:195], v[220:223], v[20:23]
    v_exp_f32 v226, v90
    v_mfma_f32_16x16x32_bf16 v[28:31], v[196:199], v[220:223], v[28:31]
    v_pk_add_f32 v[244:245], v[244:245], v[224:225]
    v_exp_f32 v227, v91
    v_mfma_f32_16x16x32_bf16 v[36:39], v[200:203], v[220:223], v[36:39]
    v_cvt_pk_bf16_f32 v218, v224, v225
    v_mfma_f32_16x16x32_bf16 v[44:47], v[204:207], v[220:223], v[44:47]
    v_pk_add_f32 v[244:245], v[244:245], v[226:227]
    v_mfma_f32_16x16x32_bf16 v[52:55], v[208:211], v[220:223], v[52:55]
    v_cvt_pk_bf16_f32 v219, v226, v227
    s_add_u32 s9, s9, 1
    v_mfma_f32_16x16x32_bf16 v[60:63], v[212:215], v[220:223], v[60:63]
L_ph4:
    s_barrier
    s_cmp_ge_u32 s9, s10
    s_cbranch_scc1 L_bnd4
    ds_read_b128 v[168:171], v228 offset:32768
    ds_read_b128 v[172:175], v229 offset:32768
    ds_read_b128 v[176:179], v230 offset:32768
    ds_read_b128 v[180:183], v231 offset:32768
    v_exp_f32 v224, v84
    v_exp_f32 v225, v85
    v_exp_f32 v226, v86
    v_exp_f32 v227, v87
    v_cvt_pk_bf16_f32 v220, v224, v225
    s_waitcnt lgkmcnt(3)
    v_mfma_f32_16x16x32_bf16 v[64:67], v[168:171], v[104:107], v[96:99]
    v_mfma_f32_16x16x32_bf16 v[68:71], v[168:171], v[120:123], v[100:103]
    ds_read_b128 v[168:171], v228 offset:36864
    v_pk_add_f32 v[246:247], v[224:225], v[226:227]
    s_waitcnt lgkmcnt(3)
    v_mfma_f32_16x16x32_bf16 v[64:67], v[172:175], v[108:111], v[64:67]
    v_cvt_pk_bf16_f32 v221, v226, v227
    v_mfma_f32_16x16x32_bf16 v[68:71], v[172:175], v[124:127], v[68:71]
    ds_read_b128 v[172:175], v229 offset:36864
    ds_read_b64_tr_b16 v[184:185], v232 offset:24576
    v_exp_f32 v224, v92
    s_waitcnt lgkmcnt(4)
    v_mfma_f32_16x16x32_bf16 v[64:67], v[176:179], v[112:115], v[64:67]
    ds_read_b64_tr_b16 v[186:187], v232 offset:28672
    v_exp_f32 v225, v93
    v_mfma_f32_16x16x32_bf16 v[68:71], v[176:179], v[128:131], v[68:71]
    ds_read_b128 v[176:179], v230 offset:36864
    ds_read_b64_tr_b16 v[188:189], v233 offset:24576
    v_exp_f32 v226, v94
    s_waitcnt lgkmcnt(6)
    v_mfma_f32_16x16x32_bf16 v[64:67], v[180:183], v[116:119], v[64:67]
    ds_read_b64_tr_b16 v[190:191], v233 offset:28672
    v_pk_add_f32 v[246:247], v[246:247], v[224:225]
    v_mfma_f32_16x16x32_bf16 v[68:71], v[180:183], v[132:135], v[68:71]
    ds_read_b128 v[180:183], v231 offset:36864
    ds_read_b64_tr_b16 v[192:193], v234 offset:24576
    v_exp_f32 v227, v95
    s_waitcnt lgkmcnt(8)
    v_mfma_f32_16x16x32_bf16 v[72:75], v[168:171], v[104:107], v[96:99]
    ds_read_b64_tr_b16 v[194:195], v234 offset:28672
    v_cvt_pk_bf16_f32 v222, v224, v225
    v_mfma_f32_16x16x32_bf16 v[76:79], v[168:171], v[120:123], v[100:103]
    ds_read_b64_tr_b16 v[196:197], v235 offset:24576
    v_pk_add_f32 v[246:247], v[246:247], v[226:227]
    s_waitcnt lgkmcnt(9)
    v_mfma_f32_16x16x32_bf16 v[72:75], v[172:175], v[108:111], v[72:75]
    ds_read_b64_tr_b16 v[198:199], v235 offset:28672
    v_cvt_pk_bf16_f32 v223, v226, v227
    v_mfma_f32_16x16x32_bf16 v[76:79], v[172:175], v[124:127], v[76:79]
    ds_read_b64_tr_b16 v[200:201], v236 offset:24576
    v_max3_f32 v248, v244, v245, v246
    s_waitcnt lgkmcnt(8)
    v_mfma_f32_16x16x32_bf16 v[72:75], v[176:179], v[112:115], v[72:75]
    ds_read_b64_tr_b16 v[202:203], v236 offset:28672
    v_max_f32 v248, v248, v247
    v_mfma_f32_16x16x32_bf16 v[76:79], v[176:179], v[128:131], v[76:79]
    ds_read_b64_tr_b16 v[204:205], v237 offset:24576
    v_cmp_lt_f32 vcc, s15, v248
    s_waitcnt lgkmcnt(7)
    v_mfma_f32_16x16x32_bf16 v[72:75], v[180:183], v[116:119], v[72:75]
    ds_read_b64_tr_b16 v[206:207], v237 offset:28672
    v_mfma_f32_16x16x32_bf16 v[76:79], v[180:183], v[132:135], v[76:79]
    ds_read_b64_tr_b16 v[208:209], v238 offset:24576
    s_cbranch_vccnz L_slow4
L_slow4_ret:
    v_mfma_f32_16x16x32_bf16 v[0:3], v[184:187], v[216:219], v[0:3]
    ds_read_b64_tr_b16 v[210:211], v238 offset:28672
    v_pk_add_f32 v[240:241], v[240:241], v[244:245]
    s_cmp_eq_u32 s9, s11
    v_mfma_f32_16x16x32_bf16 v[8:11], v[188:191], v[216:219], v[8:11]
    ds_read_b64_tr_b16 v[212:213], v239 offset:24576
    v_pk_add_f32 v[242:243], v[242:243], v[246:247]
    s_cbranch_scc1 L_mask4
L_mask4_ret:
    s_waitcnt lgkmcnt(9)
    v_mfma_f32_16x16x32_bf16 v[16:19], v[192:195], v[216:219], v[16:19]
    ds_read_b64_tr_b16 v[214:215], v239 offset:28672
    v_exp_f32 v224, v64
    s_waitcnt lgkmcnt(8)
    v_mfma_f32_16x16x32_bf16 v[24:27], v[196:199], v[216:219], v[24:27]
    v_exp_f32 v225, v65
    s_waitcnt lgkmcnt(6)
    v_mfma_f32_16x16x32_bf16 v[32:35], v[200:203], v[216:219], v[32:35]
    v_exp_f32 v226, v66
    s_waitcnt lgkmcnt(4)
    v_mfma_f32_16x16x32_bf16 v[40:43], v[204:207], v[216:219], v[40:43]
    v_exp_f32 v227, v67
    s_waitcnt lgkmcnt(2)
    v_mfma_f32_16x16x32_bf16 v[48:51], v[208:211], v[216:219], v[48:51]
    v_pk_add_f32 v[244:245], v[224:225], v[226:227]
    s_waitcnt lgkmcnt(0)
    v_mfma_f32_16x16x32_bf16 v[56:59], v[212:215], v[216:219], v[56:59]
    v_mfma_f32_16x16x32_bf16 v[4:7], v[184:187], v[220:223], v[4:7]
    v_cvt_pk_bf16_f32 v216, v224, v225
    v_cvt_pk_bf16_f32 v217, v226, v227
    v_exp_f32 v224, v72
    v_mfma_f32_16x16x32_bf16 v[12:15], v[188:191], v[220:223], v[12:15]
    v_exp_f32 v225, v73
    s_cmp_ge_i32 s9, s89
    s_cbranch_scc1 L_tick4
L_tick4_ret:
    v_mfma_f32_16x16x32_bf16 v[20:23], v[192:195], v[220:223], v[20:23]
    v_exp_f32 v226, v74
    v_mfma_f32_16x16x32_bf16 v[28:31], v[196:199], v[220:223], v[28:31]
    v_pk_add_f32 v[244:245], v[244:245], v[224:225]
    v_exp_f32 v227, v75
    v_mfma_f32_16x16x32_bf16 v[36:39], v[200:203], v[220:223], v[36:39]
    v_cvt_pk_bf16_f32 v218, v224, v225
    v_mfma_f32_16x16x32_bf16 v[44:47], v[204:207], v[220:223], v[44:47]
    v_pk_add_f32 v[244:245], v[244:245], v[226:227]
    v_mfma_f32_16x16x32_bf16 v[52:55], v[208:211], v[220:223], v[52:55]
    v_cvt_pk_bf16_f32 v219, v226, v227
    s_add_u32 s9, s9, 1
    v_mfma_f32_16x16x32_bf16 v[60:63], v[212:215], v[220:223], v[60:63]
L_ph5:
    s_barrier
    s_cmp_ge_u32 s9, s10
    s_cbranch_scc1 L_bnd5
    ds_read_b128 v[168:171], v228 offset:40960
    ds_read_b128 v[172:175], v229 offset:40960
    ds_read_b128 v[176:179], v230 offset:40960
    ds_read_b128 v[180:183], v231 offset:40960
    v_exp_f32 v224, v68
    v_exp_f32 v225, v69
    v_exp_f32 v226, v70
    v_exp_f32 v227, v71
    v_cvt_pk_bf16_f32 v220, v224, v225
    s_waitcnt lgkmcnt(3)
    v_mfma_f32_16x16x32_bf16 v[80:83], v[168:171], v[104:107], v[96:99]
    v_mfma_f32_16x16x32_bf16 v[84:87], v[168:171], v[120:123], v[100:103]
    ds_read_b128 v[168:171], v228 offset:45056
    v_pk_add_f32 v[246:247], v[224:225], v[226:227]
    s_waitcnt lgkmcnt(3)
    v_mfma_f32_16x16x32_bf16 v[80:83], v[172:175], v[108:111], v[80:83]
    v_cvt_pk_bf16_f32 v221, v226, v227
    v_mfma_f32_16x16x32_bf16 v[84:87], v[172:175], v[124:127], v[84:87]
    ds_read_b128 v[172:175], v229 offset:45056
    ds_read_b64_tr_b16 v[184:185], v232 offset:32768
    v_exp_f32 v224, v76
    s_waitcnt lgkmcnt(4)
    v_mfma_f32_16x16x32_bf16 v[80:83], v[176:179], v[112:115], v[80:83]
    ds_read_b64_tr_b16 v[186:187], v232 offset:36864
    v_exp_f32 v225, v77
    v_mfma_f32_16x16x32_bf16 v[84:87], v[176:179], v[128:131], v[84:87]
    ds_read_b128 v[176:179], v230 offset:45056
    ds_read_b64_tr_b16 v[188:189], v233 offset:32768
    v_exp_f32 v226, v78
    s_waitcnt lgkmcnt(6)
    v_mfma_f32_16x16x32_bf16 v[80:83], v[180:183], v[116:119], v[80:83]
    ds_read_b64_tr_b16 v[190:191], v233 offset:36864
    v_pk_add_f32 v[246:247], v[246:247], v[224:225]
    v_mfma_f32_16x16x32_bf16 v[84:87], v[180:183], v[132:135], v[84:87]
    ds_read_b128 v[180:183], v231 offset:45056
    ds_read_b64_tr_b16 v[192:193], v234 offset:32768
    v_exp_f32 v227, v79
    s_waitcnt lgkmcnt(8)
    v_mfma_f32_16x16x32_bf16 v[88:91], v[168:171], v[104:107], v[96:99]
    ds_read_b64_tr_b16 v[194:195], v234 offset:36864
    v_cvt_pk_bf16_f32 v222, v224, v225
    v_mfma_f32_16x16x32_bf16 v[92:95], v[168:171], v[120:123], v[100:103]
    ds_read_b64_tr_b16 v[196:197], v235 offset:32768
    v_pk_add_f32 v[246:247], v[246:247], v[226:227]
    s_waitcnt lgkmcnt(9)
    v_mfma_f32_16x16x32_bf16 v[88:91], v[172:175], v[108:111], v[88:91]
    ds_read_b64_tr_b16 v[198:199], v235 offset:36864
    v_cvt_pk_bf16_f32 v223, v226, v227
    v_mfma_f32_16x16x32_bf16 v[92:95], v[172:175], v[124:127], v[92:95]
    ds_read_b64_tr_b16 v[200:201], v236 offset:32768
    v_max3_f32 v248, v244, v245, v246
    s_waitcnt lgkmcnt(8)
    v_mfma_f32_16x16x32_bf16 v[88:91], v[176:179], v[112:115], v[88:91]
    ds_read_b64_tr_b16 v[202:203], v236 offset:36864
    v_max_f32 v248, v248, v247
    v_mfma_f32_16x16x32_bf16 v[92:95], v[176:179], v[128:131], v[92:95]
    ds_read_b64_tr_b16 v[204:205], v237 offset:32768
    v_cmp_lt_f32 vcc, s15, v248
    s_waitcnt lgkmcnt(7)
    v_mfma_f32_16x16x32_bf16 v[88:91], v[180:183], v[116:119], v[88:91]
    ds_read_b64_tr_b16 v[206:207], v237 offset:36864
    v_mfma_f32_16x16x32_bf16 v[92:95], v[180:183], v[132:135], v[92:95]
    ds_read_b64_tr_b16 v[208:209], v238 offset:32768
    s_cbranch_vccnz L_slow5
L_slow5_ret:
    v_mfma_f32_16x16x32_bf16 v[0:3], v[184:187], v[216:219], v[0:3]
    ds_read_b64_tr_b16 v[210:211], v238 offset:36864
    v_pk_add_f32 v[240:241], v[240:241], v[244:245]
    s_cmp_eq_u32 s9, s11
    v_mfma_f32_16x16x32_bf16 v[8:11], v[188:191], v[216:219], v[8:11]
    ds_read_b64_tr_b16 v[212:213], v239 offset:32768
    v_pk_add_f32 v[242:243], v[242:243], v[246:247]
    s_cbranch_scc1 L_mask5
L_mask5_ret:
    s_waitcnt lgkmcnt(9)
    v_mfma_f32_16x16x32_bf16 v[16:19], v[192:195], v[216:219], v[16:19]
    ds_read_b64_tr_b16 v[214:215], v239 offset:36864
    v_exp_f32 v224, v80
    s_waitcnt lgkmcnt(8)
    v_mfma_f32_16x16x32_bf16 v[24:27], v[196:199], v[216:219], v[24:27]
    v_exp_f32 v225, v81
    s_waitcnt lgkmcnt(6)
    v_mfma_f32_16x16x32_bf16 v[32:35], v[200:203], v[216:219], v[32:35]
    v_exp_f32 v226, v82
    s_waitcnt lgkmcnt(4)
    v_mfma_f32_16x16x32_bf16 v[40:43], v[204:207], v[216:219], v[40:43]
    v_exp_f32 v227, v83
    s_waitcnt lgkmcnt(2)
    v_mfma_f32_16x16x32_bf16 v[48:51], v[208:211], v[216:219], v[48:51]
    v_pk_add_f32 v[244:245], v[224:225], v[226:227]
    s_waitcnt lgkmcnt(0)
    v_mfma_f32_16x16x32_bf16 v[56:59], v[212:215], v[216:219], v[56:59]
    v_mfma_f32_16x16x32_bf16 v[4:7], v[184:187], v[220:223], v[4:7]
    v_cvt_pk_bf16_f32 v216, v224, v225
    v_cvt_pk_bf16_f32 v217, v226, v227
    v_exp_f32 v224, v88
    v_mfma_f32_16x16x32_bf16 v[12:15], v[188:191], v[220:223], v[12:15]
    v_exp_f32 v225, v89
    s_cmp_ge_i32 s9, s89
    s_cbranch_scc1 L_tick5
L_tick5_ret:
    v_mfma_f32_16x16x32_bf16 v[20:23], v[192:195], v[220:223], v[20:23]
    v_exp_f32 v226, v90
    v_mfma_f32_16x16x32_bf16 v[28:31], v[196:199], v[220:223], v[28:31]
    v_pk_add_f32 v[244:245], v[244:245], v[224:225]
    v_exp_f32 v227, v91
    v_mfma_f32_16x16x32_bf16 v[36:39], v[200:203], v[220:223], v[36:39]
    v_cvt_pk_bf16_f32 v218, v224, v225
    v_mfma_f32_16x16x32_bf16 v[44:47], v[204:207], v[220:223], v[44:47]
    v_pk_add_f32 v[244:245], v[244:245], v[226:227]
    v_mfma_f32_16x16x32_bf16 v[52:55], v[208:211], v[220:223], v[52:55]
    v_cvt_pk_bf16_f32 v219, v226, v227
    s_add_u32 s9, s9, 1
    v_mfma_f32_16x16x32_bf16 v[60:63], v[212:215], v[220:223], v[60:63]
    s_branch L_ph0
L_slow0:
    s_nop 7
    v_max3_f32 v248, v80, v81, v82
    v_max3_f32 v248, v248, v83, v88
    v_max3_f32 v248, v248, v89, v90
    v_max_f32 v248, v248, v91
    v_max3_f32 v252, v84, v85, v86
    v_max3_f32 v252, v252, v87, v92
    v_max3_f32 v252, v252, v93, v94
    v_max_f32 v252, v252, v95
    v_mov_b32 v249, v248
    v_mov_b32 v253, v252
    s_nop 1
    v_permlane16_swap_b32 v248, v249
    v_permlane16_swap_b32 v252, v253
    s_nop 1
    v_max_f32 v248, v248, v249
    v_max_f32 v252, v252, v253
    v_mov_b32 v249, v248
    v_mov_b32 v253, v252
    s_nop 1
    v_permlane32_swap_b32 v248, v249
    v_permlane32_swap_b32 v252, v253
    s_nop 1
    v_max_f32 v248, v248, v249
    v_max_f32 v252, v252, v253
    v_max_f32 v248, 0, v248
    v_exp_f32 v249, -v248
    v_max_f32 v252, 0, v252
    v_exp_f32 v253, -v252
    v_sub_f32 v80, v80, v248
    v_sub_f32 v81, v81, v248
    v_sub_f32 v82, v82, v248
    v_sub_f32 v83, v83, v248
    v_sub_f32 v88, v88, v248
    v_sub_f32 v89, v89, v248
    v_sub_f32 v90, v90, v248
    v_sub_f32 v91, v91, v248
    v_sub_f32 v96, v96, v248
    v_sub_f32 v97, v97, v248
    v_sub_f32 v98, v98, v248
    v_sub_f32 v99, v99, v248
    v_sub_f32 v64, v64, v248
    v_sub_f32 v65, v65, v248
    v_sub_f32 v66, v66, v248
    v_sub_f32 v67, v67, v248
    v_sub_f32 v72, v72, v248
    v_sub_f32 v73, v73, v248
    v_sub_f32 v74, v74, v248
    v_sub_f32 v75, v75, v248
    v_mul_f32 v0, v0, v249
    v_mul_f32 v1, v1, v249
    v_mul_f32 v2, v2, v249
    v_mul_f32 v3, v3, v249
    v_mul_f32 v8, v8, v249
    v_mul_f32 v9, v9, v249
    v_mul_f32 v10, v10, v249
    v_mul_f32 v11, v11, v249
    v_mul_f32 v16, v16, v249
    v_mul_f32 v17, v17, v249
    v_mul_f32 v18, v18, v249
    v_mul_f32 v19, v19, v249
    v_mul_f32 v24, v24, v249
    v_mul_f32 v25, v25, v249
    v_mul_f32 v26, v26, v249
    v_mul_f32 v27, v27, v249
    v_mul_f32 v32, v32, v249
    v_mul_f32 v33, v33, v249
    v_mul_f32 v34, v34, v249
    v_mul_f32 v35, v35, v249
    v_mul_f32 v40, v40, v249
    v_mul_f32 v41, v41, v249
    v_mul_f32 v42, v42, v249
    v_mul_f32 v43, v43, v249
    v_mul_f32 v48, v48, v249
    v_mul_f32 v49, v49, v249
    v_mul_f32 v50, v50, v249
    v_mul_f32 v51, v51, v249
    v_mul_f32 v56, v56, v249
    v_mul_f32 v57, v57, v249
    v_mul_f32 v58, v58, v249
    v_mul_f32 v59, v59, v249
    v_mul_f32 v240, v240, v249
    v_mul_f32 v241, v241, v249
    v_sub_f32 v84, v84, v252
    v_sub_f32 v85, v85, v252
    v_sub_f32 v86, v86, v252
    v_sub_f32 v87, v87, v252
    v_sub_f32 v92, v92, v252
    v_sub_f32 v93, v93, v252
    v_sub_f32 v94, v94, v252
    v_sub_f32 v95, v95, v252
    v_sub_f32 v100, v100, v252
    v_sub_f32 v101, v101, v252
    v_sub_f32 v102, v102, v252
    v_sub_f32 v103, v103, v252
    v_sub_f32 v68, v68, v252
    v_sub_f32 v69, v69, v252
    v_sub_f32 v70, v70, v252
    v_sub_f32 v71, v71, v252
    v_sub_f32 v76, v76, v252
    v_sub_f32 v77, v77, v252
    v_sub_f32 v78, v78, v252
    v_sub_f32 v79, v79, v252
    v_mul_f32 v4, v4, v253
    v_mul_f32 v5, v5, v253
    v_mul_f32 v6, v6, v253
    v_mul_f32 v7, v7, v253
    v_mul_f32 v12, v12, v253
    v_mul_f32 v13, v13, v253
    v_mul_f32 v14, v14, v253
    v_mul_f32 v15, v15, v253
    v_mul_f32 v20, v20, v253
    v_mul_f32 v21, v21, v253
    v_mul_f32 v22, v22, v253
    v_mul_f32 v23, v23, v253
    v_mul_f32 v28, v28, v253
    v_mul_f32 v29, v29, v253
    v_mul_f32 v30, v30, v253
    v_mul_f32 v31, v31, v253
    v_mul_f32 v36, v36, v253
    v_mul_f32 v37, v37, v253
    v_mul_f32 v38, v38, v253
    v_mul_f32 v39, v39, v253
    v_mul_f32 v44, v44, v253
    v_mul_f32 v45, v45, v253
    v_mul_f32 v46, v46, v253
    v_mul_f32 v47, v47, v253
    v_mul_f32 v52, v52, v253
    v_mul_f32 v53, v53, v253
    v_mul_f32 v54, v54, v253
    v_mul_f32 v55, v55, v253
    v_mul_f32 v60, v60, v253
    v_mul_f32 v61, v61, v253
    v_mul_f32 v62, v62, v253
    v_mul_f32 v63, v63, v253
    v_mul_f32 v242, v242, v253
    v_mul_f32 v243, v243, v253
    v_exp_f32 v224, v80
    v_exp_f32 v225, v81
    v_exp_f32 v226, v82
    v_exp_f32 v227, v83
    v_cvt_pk_bf16_f32 v216, v224, v225
    v_pk_add_f32 v[244:245], v[224:225], v[226:227]
    v_cvt_pk_bf16_f32 v217, v226, v227
    v_exp_f32 v224, v88
    v_exp_f32 v225, v89
    v_exp_f32 v226, v90
    v_pk_add_f32 v[244:245], v[244:245], v[224:225]
    v_exp_f32 v227, v91
    v_cvt_pk_bf16_f32 v218, v224, v225
    v_pk_add_f32 v[244:245], v[244:245], v[226:227]
    v_cvt_pk_bf16_f32 v219, v226, v227
    v_exp_f32 v224, v84
    v_exp_f32 v225, v85
    v_exp_f32 v226, v86
    v_exp_f32 v227, v87
    v_cvt_pk_bf16_f32 v220, v224, v225
    v_pk_add_f32 v[246:247], v[224:225], v[226:227]
    v_cvt_pk_bf16_f32 v221, v226, v227
    v_exp_f32 v224, v92
    v_exp_f32 v225, v93
    v_exp_f32 v226, v94
    v_pk_add_f32 v[246:247], v[246:247], v[224:225]
    v_exp_f32 v227, v95
    v_cvt_pk_bf16_f32 v222, v224, v225
    v_pk_add_f32 v[246:247], v[246:247], v[226:227]
    v_cvt_pk_bf16_f32 v223, v226, v227
    s_nop 1
    s_branch L_slow0_ret
L_mask0:
    s_nop 7
    v_lshrrev_b32 v250, 4, v251
    v_lshlrev_b32 v250, 2, v250
    v_mov_b32 v248, 0xff800000
    v_add_u32 v249, 0, v250
    v_cmp_gt_u32 vcc, s12, v249
    s_nop 1
    v_cndmask_b32 v64, v248, v64, vcc
    v_cndmask_b32 v68, v248, v68, vcc
    v_add_u32 v249, 1, v250
    v_cmp_gt_u32 vcc, s12, v249
    s_nop 1
    v_cndmask_b32 v65, v248, v65, vcc
    v_cndmask_b32 v69, v248, v69, vcc
    v_add_u32 v249, 2, v250
    v_cmp_gt_u32 vcc, s12, v249
    s_nop 1
    v_cndmask_b32 v66, v248, v66, vcc
    v_cndmask_b32 v70, v248, v70, vcc
    v_add_u32 v249, 3, v250
    v_cmp_gt_u32 vcc, s12, v249
    s_nop 1
    v_cndmask_b32 v67, v248, v67, vcc
    v_cndmask_b32 v71, v248, v71, vcc
    v_add_u32 v249, 16, v250
    v_cmp_gt_u32 vcc, s12, v249
    s_nop 1
    v_cndmask_b32 v72, v248, v72, vcc
    v_cndmask_b32 v76, v248, v76, vcc
    v_add_u32 v249, 17, v250
    v_cmp_gt_u32 vcc, s12, v249
    s_nop 1
    v_cndmask_b32 v73, v248, v73, vcc
    v_cndmask_b32 v77, v248, v77, vcc
    v_add_u32 v249, 18, v250
    v_cmp_gt_u32 vcc, s12, v249
    s_nop 1
    v_cndmask_b32 v74, v248, v74, vcc
    v_cndmask_b32 v78, v248, v78, vcc
    v_add_u32 v249, 19, v250
    v_cmp_gt_u32 vcc, s12, v249
    s_nop 1
    v_cndmask_b32 v75, v248, v75, vcc
    v_cndmask_b32 v79, v248, v79, vcc
    s_branch L_mask0_ret
L_tick0:
    buffer_load_dword v254, off, s[40:43], s91 sc1
    s_mov_b32 s89, 0x7fffffff
    s_branch L_tick0_ret
L_bnd0:
    ds_read_b64_tr_b16 v[184:185], v232 offset:40960
    ds_read_b64_tr_b16 v[186:187], v232 offset:45056
    ds_read_b64_tr_b16 v[188:189], v233 offset:40960
    ds_read_b64_tr_b16 v[190:191], v233 offset:45056
    ds_read_b64_tr_b16 v[192:193], v234 offset:40960
    ds_read_b64_tr_b16 v[194:195], v234 offset:45056
    ds_read_b64_tr_b16 v[196:197], v235 offset:40960
    ds_read_b64_tr_b16 v[198:199], v235 offset:45056
    ds_read_b64_tr_b16 v[200:201], v236 offset:40960
    ds_read_b64_tr_b16 v[202:203], v236 offset:45056
    ds_read_b64_tr_b16 v[204:205], v237 offset:40960
    ds_read_b64_tr_b16 v[206:207], v237 offset:45056
    v_mov_b32 v64, v80
    v_mov_b32 v65, v81
    v_mov_b32 v66, v82
    v_mov_b32 v67, v83
    v_mov_b32 v68, v84
    v_mov_b32 v69, v85
    v_mov_b32 v70, v86
    v_mov_b32 v71, v87
    v_mov_b32 v72, v88
    v_mov_b32 v73, v89
    v_mov_b32 v74, v90
    v_mov_b32 v75, v91
    v_mov_b32 v76, v92
    v_mov_b32 v77, v93
    v_mov_b32 v78, v94
    v_mov_b32 v79, v95
    s_waitcnt lgkmcnt(8)
    ds_read_b64_tr_b16 v[208:209], v238 offset:40960
    ds_read_b64_tr_b16 v[210:211], v238 offset:45056
    ds_read_b64_tr_b16 v[212:213], v239 offset:40960
    ds_read_b64_tr_b16 v[214:215], v239 offset:45056
    s_branch L_last
L_slow1:
    s_nop 7
    v_max3_f32 v248, v64, v65, v66
    v_max3_f32 v248, v248, v67, v72
    v_max3_f32 v248, v248, v73, v74
    v_max_f32 v248, v248, v75
    v_max3_f32 v252, v68, v69, v70
    v_max3_f32 v252, v252, v71, v76
    v_max3_f32 v252, v252, v77, v78
    v_max_f32 v252, v252, v79
    v_mov_b32 v249, v248
    v_mov_b32 v253, v252
    s_nop 1
    v_permlane16_swap_b32 v248, v249
    v_permlane16_swap_b32 v252, v253
    s_nop 1
    v_max_f32 v248, v248, v249
    v_max_f32 v252, v252, v253
    v_mov_b32 v249, v248
    v_mov_b32 v253, v252
    s_nop 1
    v_permlane32_swap_b32 v248, v249
    v_permlane32_swap_b32 v252, v253
    s_nop 1
    v_max_f32 v248, v248, v249
    v_max_f32 v252, v252, v253
    v_max_f32 v248, 0, v248
    v_exp_f32 v249, -v248
    v_max_f32 v252, 0, v252
    v_exp_f32 v253, -v252
    v_sub_f32 v64, v64, v248
    v_sub_f32 v65, v65, v248
    v_sub_f32 v66, v66, v248
    v_sub_f32 v67, v67, v248
    v_sub_f32 v72, v72, v248
    v_sub_f32 v73, v73, v248
    v_sub_f32 v74, v74, v248
    v_sub_f32 v75, v75, v248
    v_sub_f32 v96, v96, v248
    v_sub_f32 v97, v97, v248
    v_sub_f32 v98, v98, v248
    v_sub_f32 v99, v99, v248
    v_sub_f32 v80, v80, v248
    v_sub_f32 v81, v81, v248
    v_sub_f32 v82, v82, v248
    v_sub_f32 v83, v83, v248
    v_sub_f32 v88, v88, v248
    v_sub_f32 v89, v89, v248
    v_sub_f32 v90, v90, v248
    v_sub_f32 v91, v91, v248
    v_mul_f32 v0, v0, v249
    v_mul_f32 v1, v1, v249
    v_mul_f32 v2, v2, v249
    v_mul_f32 v3, v3, v249
    v_mul_f32 v8, v8, v249
    v_mul_f32 v9, v9, v249
    v_mul_f32 v10, v10, v249
    v_mul_f32 v11, v11, v249
    v_mul_f32 v16, v16, v249
    v_mul_f32 v17, v17, v249
    v_mul_f32 v18, v18, v249
    v_mul_f32 v19, v19, v249
    v_mul_f32 v24, v24, v249
    v_mul_f32 v25, v25, v249
    v_mul_f32 v26, v26, v249
    v_mul_f32 v27, v27, v249
    v_mul_f32 v32, v32, v249
    v_mul_f32 v33, v33, v249
    v_mul_f32 v34, v34, v249
    v_mul_f32 v35, v35, v249
    v_mul_f32 v40, v40, v249
    v_mul_f32 v41, v41, v249
    v_mul_f32 v42, v42, v249
    v_mul_f32 v43, v43, v249
    v_mul_f32 v48, v48, v249
    v_mul_f32 v49, v49, v249
    v_mul_f32 v50, v50, v249
    v_mul_f32 v51, v51, v249
    v_mul_f32 v56, v56, v249
    v_mul_f32 v57, v57, v249
    v_mul_f32 v58, v58, v249
    v_mul_f32 v59, v59, v249
    v_mul_f32 v240, v240, v249
    v_mul_f32 v241, v241, v249
    v_sub_f32 v68, v68, v252
    v_sub_f32 v69, v69, v252
    v_sub_f32 v70, v70, v252
    v_sub_f32 v71, v71, v252
    v_sub_f32 v76, v76, v252
    v_sub_f32 v77, v77, v252
    v_sub_f32 v78, v78, v252
    v_sub_f32 v79, v79, v252
    v_sub_f32 v100, v100, v252
    v_sub_f32 v101, v101, v252
    v_sub_f32 v102, v102, v252
    v_sub_f32 v103, v103, v252
    v_sub_f32 v84, v84, v252
    v_sub_f32 v85, v85, v252
    v_sub_f32 v86, v86, v252
    v_sub_f32 v87, v87, v252
    v_sub_f32 v92, v92, v252
    v_sub_f32 v93, v93, v252
    v_sub_f32 v94, v94, v252
    v_sub_f32 v95, v95, v252
    v_mul_f32 v4, v4, v253
    v_mul_f32 v5, v5, v253
    v_mul_f32 v6, v6, v253
    v_mul_f32 v7, v7, v253
    v_mul_f32 v12, v12, v253
    v_mul_f32 v13, v13, v253
    v_mul_f32 v14, v14, v253
    v_mul_f32 v15, v15, v253
    v_mul_f32 v20, v20, v253
    v_mul_f32 v21, v21, v253
    v_mul_f32 v22, v22, v253
    v_mul_f32 v23, v23, v253
    v_mul_f32 v28, v28, v253
    v_mul_f32 v29, v29, v253
    v_mul_f32 v30, v30, v253
    v_mul_f32 v31, v31, v253
    v_mul_f32 v36, v36, v253
    v_mul_f32 v37, v37, v253
    v_mul_f32 v38, v38, v253
    v_mul_f32 v39, v39, v253
    v_mul_f32 v44, v44, v253
    v_mul_f32 v45, v45, v253
    v_mul_f32 v46, v46, v253
    v_mul_f32 v47, v47, v253
    v_mul_f32 v52, v52, v253
    v_mul_f32 v53, v53, v253
    v_mul_f32 v54, v54, v253
    v_mul_f32 v55, v55, v253
    v_mul_f32 v60, v60, v253
    v_mul_f32 v61, v61, v253
    v_mul_f32 v62, v62, v253
    v_mul_f32 v63, v63, v253
    v_mul_f32 v242, v242, v253
    v_mul_f32 v243, v243, v253
    v_exp_f32 v224, v64
    v_exp_f32 v225, v65
    v_exp_f32 v226, v66
    v_exp_f32 v227, v67
    v_cvt_pk_bf16_f32 v216, v224, v225
    v_pk_add_f32 v[244:245], v[224:225], v[226:227]
    v_cvt_pk_bf16_f32 v217, v226, v227
    v_exp_f32 v224, v72
    v_exp_f32 v225, v73
    v_exp_f32 v226, v74
    v_pk_add_f32 v[244:245], v[244:245], v[224:225]
    v_exp_f32 v227, v75
    v_cvt_pk_bf16_f32 v218, v224, v225
    v_pk_add_f32 v[244:245], v[244:245], v[226:227]
    v_cvt_pk_bf16_f32 v219, v226, v227
    v_exp_f32 v224, v68
    v_exp_f32 v225, v69
    v_exp_f32 v226, v70
    v_exp_f32 v227, v71
    v_cvt_pk_bf16_f32 v220, v224, v225
    v_pk_add_f32 v[246:247], v[224:225], v[226:227]
    v_cvt_pk_bf16_f32 v221, v226, v227
    v_exp_f32 v224, v76
    v_exp_f32 v225, v77
    v_exp_f32 v226, v78
    v_pk_add_f32 v[246:247], v[246:247], v[224:225]
    v_exp_f32 v227, v79
    v_cvt_pk_bf16_f32 v222, v224, v225
    v_pk_add_f32 v[246:247], v[246:247], v[226:227]
    v_cvt_pk_bf16_f32 v223, v226, v227
    s_nop 1
    s_branch L_slow1_ret
L_mask1:
    s_nop 7
    v_lshrrev_b32 v250, 4, v251
    v_lshlrev_b32 v250, 2, v250
    v_mov_b32 v248, 0xff800000
    v_add_u32 v249, 0, v250
    v_cmp_gt_u32 vcc, s12, v249
    s_nop 1
    v_cndmask_b32 v80, v248, v80, vcc
    v_cndmask_b32 v84, v248, v84, vcc
    v_add_u32 v249, 1, v250
    v_cmp_gt_u32 vcc, s12, v249
    s_nop 1
    v_cndmask_b32 v81, v248, v81, vcc
    v_cndmask_b32 v85, v248, v85, vcc
    v_add_u32 v249, 2, v250
    v_cmp_gt_u32 vcc, s12, v249
    s_nop 1
    v_cndmask_b32 v82, v248, v82, vcc
    v_cndmask_b32 v86, v248, v86, vcc
    v_add_u32 v249, 3, v250
    v_cmp_gt_u32 vcc, s12, v249
    s_nop 1
    v_cndmask_b32 v83, v248, v83, vcc
    v_cndmask_b32 v87, v248, v87, vcc
    v_add_u32 v249, 16, v250
    v_cmp_gt_u32 vcc, s12, v249
    s_nop 1
    v_cndmask_b32 v88, v248, v88, vcc
    v_cndmask_b32 v92, v248, v92, vcc
    v_add_u32 v249, 17, v250
    v_cmp_gt_u32 vcc, s12, v249
    s_nop 1
    v_cndmask_b32 v89, v248, v89, vcc
    v_cndmask_b32 v93, v248, v93, vcc
    v_add_u32 v249, 18, v250
    v_cmp_gt_u32 vcc, s12, v249
    s_nop 1
    v_cndmask_b32 v90, v248, v90, vcc
    v_cndmask_b32 v94, v248, v94, vcc
    v_add_u32 v249, 19, v250
    v_cmp_gt_u32 vcc, s12, v249
    s_nop 1
    v_cndmask_b32 v91, v248, v91, vcc
    v_cndmask_b32 v95, v248, v95, vcc
    s_branch L_mask1_ret
L_tick1:
    buffer_load_dword v254, off, s[40:43], s91 sc1
    s_mov_b32 s89, 0x7fffffff
    s_branch L_tick1_ret
L_bnd1:
    ds_read_b64_tr_b16 v[184:185], v232 offset:0
    ds_read_b64_tr_b16 v[186:187], v232 offset:4096
    ds_read_b64_tr_b16 v[188:189], v233 offset:0
    ds_read_b64_tr_b16 v[190:191], v233 offset:4096
    ds_read_b64_tr_b16 v[192:193], v234 offset:0
    ds_read_b64_tr_b16 v[194:195], v234 offset:4096
    ds_read_b64_tr_b16 v[196:197], v235 offset:0
    ds_read_b64_tr_b16 v[198:199], v235 offset:4096
    ds_read_b64_tr_b16 v[200:201], v236 offset:0
    ds_read_b64_tr_b16 v[202:203], v236 offset:4096
    ds_read_b64_tr_b16 v[204:205], v237 offset:0
    ds_read_b64_tr_b16 v[206:207], v237 offset:4096
    s_waitcnt lgkmcnt(8)
    ds_read_b64_tr_b16 v[208:209], v238 offset:0
    ds_read_b64_tr_b16 v[210:211], v238 offset:4096
    ds_read_b64_tr_b16 v[212:213], v239 offset:0
    ds_read_b64_tr_b16 v[214:215], v239 offset:4096
    s_branch L_last
L_slow2:
    s_nop 7
    v_max3_f32 v248, v80, v81, v82
    v_max3_f32 v248, v248, v83, v88
    v_max3_f32 v248, v248, v89, v90
    v_max_f32 v248, v248, v91
    v_max3_f32 v252, v84, v85, v86
    v_max3_f32 v252, v252, v87, v92
    v_max3_f32 v252, v252, v93, v94
    v_max_f32 v252, v252, v95
    v_mov_b32 v249, v248
    v_mov_b32 v253, v252
    s_nop 1
    v_permlane16_swap_b32 v248, v249
    v_permlane16_swap_b32 v252, v253
    s_nop 1
    v_max_f32 v248, v248, v249
    v_max_f32 v252, v252, v253
    v_mov_b32 v249, v248
    v_mov_b32 v253, v252
    s_nop 1
    v_permlane32_swap_b32 v248, v249
    v_permlane32_swap_b32 v252, v253
    s_nop 1
    v_max_f32 v248, v248, v249
    v_max_f32 v252, v252, v253
    v_max_f32 v248, 0, v248
    v_exp_f32 v249, -v248
    v_max_f32 v252, 0, v252
    v_exp_f32 v253, -v252
    v_sub_f32 v80, v80, v248
    v_sub_f32 v81, v81, v248
    v_sub_f32 v82, v82, v248
    v_sub_f32 v83, v83, v248
    v_sub_f32 v88, v88, v248
    v_sub_f32 v89, v89, v248
    v_sub_f32 v90, v90, v248
    v_sub_f32 v91, v91, v248
    v_sub_f32 v96, v96, v248
    v_sub_f32 v97, v97, v248
    v_sub_f32 v98, v98, v248
    v_sub_f32 v99, v99, v248
    v_sub_f32 v64, v64, v248
    v_sub_f32 v65, v65, v248
    v_sub_f32 v66, v66, v248
    v_sub_f32 v67, v67, v248
    v_sub_f32 v72, v72, v248
    v_sub_f32 v73, v73, v248
    v_sub_f32 v74, v74, v248
    v_sub_f32 v75, v75, v248
    v_mul_f32 v0, v0, v249
    v_mul_f32 v1, v1, v249
    v_mul_f32 v2, v2, v249
    v_mul_f32 v3, v3, v249
    v_mul_f32 v8, v8, v249
    v_mul_f32 v9, v9, v249
    v_mul_f32 v10, v10, v249
    v_mul_f32 v11, v11, v249
    v_mul_f32 v16, v16, v249
    v_mul_f32 v17, v17, v249
    v_mul_f32 v18, v18, v249
    v_mul_f32 v19, v19, v249
    v_mul_f32 v24, v24, v249
    v_mul_f32 v25, v25, v249
    v_mul_f32 v26, v26, v249
    v_mul_f32 v27, v27, v249
    v_mul_f32 v32, v32, v249
    v_mul_f32 v33, v33, v249
    v_mul_f32 v34, v34, v249
    v_mul_f32 v35, v35, v249
    v_mul_f32 v40, v40, v249
    v_mul_f32 v41, v41, v249
    v_mul_f32 v42, v42, v249
    v_mul_f32 v43, v43, v249
    v_mul_f32 v48, v48, v249
    v_mul_f32 v49, v49, v249
    v_mul_f32 v50, v50, v249
    v_mul_f32 v51, v51, v249
    v_mul_f32 v56, v56, v249
    v_mul_f32 v57, v57, v249
    v_mul_f32 v58, v58, v249
    v_mul_f32 v59, v59, v249
    v_mul_f32 v240, v240, v249
    v_mul_f32 v241, v241, v249
    v_sub_f32 v84, v84, v252
    v_sub_f32 v85, v85, v252
    v_sub_f32 v86, v86, v252
    v_sub_f32 v87, v87, v252
    v_sub_f32 v92, v92, v252
    v_sub_f32 v93, v93, v252
    v_sub_f32 v94, v94, v252
    v_sub_f32 v95, v95, v252
    v_sub_f32 v100, v100, v252
    v_sub_f32 v101, v101, v252
    v_sub_f32 v102, v102, v252
    v_sub_f32 v103, v103, v252
    v_sub_f32 v68, v68, v252
    v_sub_f32 v69, v69, v252
    v_sub_f32 v70, v70, v252
    v_sub_f32 v71, v71, v252
    v_sub_f32 v76, v76, v252
    v_sub_f32 v77, v77, v252
    v_sub_f32 v78, v78, v252
    v_sub_f32 v79, v79, v252
    v_mul_f32 v4, v4, v253
    v_mul_f32 v5, v5, v253
    v_mul_f32 v6, v6, v253
    v_mul_f32 v7, v7, v253
    v_mul_f32 v12, v12, v253
    v_mul_f32 v13, v13, v253
    v_mul_f32 v14, v14, v253
    v_mul_f32 v15, v15, v253
    v_mul_f32 v20, v20, v253
    v_mul_f32 v21, v21, v253
    v_mul_f32 v22, v22, v253
    v_mul_f32 v23, v23, v253
    v_mul_f32 v28, v28, v253
    v_mul_f32 v29, v29, v253
    v_mul_f32 v30, v30, v253
    v_mul_f32 v31, v31, v253
    v_mul_f32 v36, v36, v253
    v_mul_f32 v37, v37, v253
    v_mul_f32 v38, v38, v253
    v_mul_f32 v39, v39, v253
    v_mul_f32 v44, v44, v253
    v_mul_f32 v45, v45, v253
    v_mul_f32 v46, v46, v253
    v_mul_f32 v47, v47, v253
    v_mul_f32 v52, v52, v253
    v_mul_f32 v53, v53, v253
    v_mul_f32 v54, v54, v253
    v_mul_f32 v55, v55, v253
    v_mul_f32 v60, v60, v253
    v_mul_f32 v61, v61, v253
    v_mul_f32 v62, v62, v253
    v_mul_f32 v63, v63, v253
    v_mul_f32 v242, v242, v253
    v_mul_f32 v243, v243, v253
    v_exp_f32 v224, v80
    v_exp_f32 v225, v81
    v_exp_f32 v226, v82
    v_exp_f32 v227, v83
    v_cvt_pk_bf16_f32 v216, v224, v225
    v_pk_add_f32 v[244:245], v[224:225], v[226:227]
    v_cvt_pk_bf16_f32 v217, v226, v227
    v_exp_f32 v224, v88
    v_exp_f32 v225, v89
    v_exp_f32 v226, v90
    v_pk_add_f32 v[244:245], v[244:245], v[224:225]
    v_exp_f32 v227, v91
    v_cvt_pk_bf16_f32 v218, v224, v225
    v_pk_add_f32 v[244:245], v[244:245], v[226:227]
    v_cvt_pk_bf16_f32 v219, v226, v227
    v_exp_f32 v224, v84
    v_exp_f32 v225, v85
    v_exp_f32 v226, v86
    v_exp_f32 v227, v87
    v_cvt_pk_bf16_f32 v220, v224, v225
    v_pk_add_f32 v[246:247], v[224:225], v[226:227]
    v_cvt_pk_bf16_f32 v221, v226, v227
    v_exp_f32 v224, v92
    v_exp_f32 v225, v93
    v_exp_f32 v226, v94
    v_pk_add_f32 v[246:247], v[246:247], v[224:225]
    v_exp_f32 v227, v95
    v_cvt_pk_bf16_f32 v222, v224, v225
    v_pk_add_f32 v[246:247], v[246:247], v[226:227]
    v_cvt_pk_bf16_f32 v223, v226, v227
    s_nop 1
    s_branch L_slow2_ret
L_mask2:
    s_nop 7
    v_lshrrev_b32 v250, 4, v251
    v_lshlrev_b32 v250, 2, v250
    v_mov_b32 v248, 0xff800000
    v_add_u32 v249, 0, v250
    v_cmp_gt_u32 vcc, s12, v249
    s_nop 1
    v_cndmask_b32 v64, v248, v64, vcc
    v_cndmask_b32 v68, v248, v68, vcc
    v_add_u32 v249, 1, v250
    v_cmp_gt_u32 vcc, s12, v249
    s_nop 1
    v_cndmask_b32 v65, v248, v65, vcc
    v_cndmask_b32 v69, v248, v69, vcc
    v_add_u32 v249, 2, v250
    v_cmp_gt_u32 vcc, s12, v249
    s_nop 1
    v_cndmask_b32 v66, v248, v66, vcc
    v_cndmask_b32 v70, v248, v70, vcc
    v_add_u32 v249, 3, v250
    v_cmp_gt_u32 vcc, s12, v249
    s_nop 1
    v_cndmask_b32 v67, v248, v67, vcc
    v_cndmask_b32 v71, v248, v71, vcc
    v_add_u32 v249, 16, v250
    v_cmp_gt_u32 vcc, s12, v249
    s_nop 1
    v_cndmask_b32 v72, v248, v72, vcc
    v_cndmask_b32 v76, v248, v76, vcc
    v_add_u32 v249, 17, v250
    v_cmp_gt_u32 vcc, s12, v249
    s_nop 1
    v_cndmask_b32 v73, v248, v73, vcc
    v_cndmask_b32 v77, v248, v77, vcc
    v_add_u32 v249, 18, v250
    v_cmp_gt_u32 vcc, s12, v249
    s_nop 1
    v_cndmask_b32 v74, v248, v74, vcc
    v_cndmask_b32 v78, v248, v78, vcc
    v_add_u32 v249, 19, v250
    v_cmp_gt_u32 vcc, s12, v249
    s_nop 1
    v_cndmask_b32 v75, v248, v75, vcc
    v_cndmask_b32 v79, v248, v79, vcc
    s_branch L_mask2_ret
L_tick2:
    buffer_load_dword v254, off, s[40:43], s91 sc1
    s_mov_b32 s89, 0x7fffffff
    s_branch L_tick2_ret
L_bnd2:
    ds_read_b64_tr_b16 v[184:185], v232 offset:8192
    ds_read_b64_tr_b16 v[186:187], v232 offset:12288
    ds_read_b64_tr_b16 v[188:189], v233 offset:8192
    ds_read_b64_tr_b16 v[190:191], v233 offset:12288
    ds_read_b64_tr_b16 v[192:193], v234 offset:8192
    ds_read_b64_tr_b16 v[194:195], v234 offset:12288
    ds_read_b64_tr_b16 v[196:197], v235 offset:8192
    ds_read_b64_tr_b16 v[198:199], v235 offset:12288
    ds_read_b64_tr_b16 v[200:201], v236 offset:8192
    ds_read_b64_tr_b16 v[202:203], v236 offset:12288
    ds_read_b64_tr_b16 v[204:205], v237 offset:8192
    ds_read_b64_tr_b16 v[206:207], v237 offset:12288
    v_mov_b32 v64, v80
    v_mov_b32 v65, v81
    v_mov_b32 v66, v82
    v_mov_b32 v67, v83
    v_mov_b32 v68, v84
    v_mov_b32 v69, v85
    v_mov_b32 v70, v86
    v_mov_b32 v71, v87
    v_mov_b32 v72, v88
    v_mov_b32 v73, v89
    v_mov_b32 v74, v90
    v_mov_b32 v75, v91
    v_mov_b32 v76, v92
    v_mov_b32 v77, v93
    v_mov_b32 v78, v94
    v_mov_b32 v79, v95
    s_waitcnt lgkmcnt(8)
    ds_read_b64_tr_b16 v[208:209], v238 offset:8192
    ds_read_b64_tr_b16 v[210:211], v238 offset:12288
    ds_read_b64_tr_b16 v[212:213], v239 offset:8192
    ds_read_b64_tr_b16 v[214:215], v239 offset:12288
    s_branch L_last
L_slow3:
    s_nop 7
    v_max3_f32 v248, v64, v65, v66
    v_max3_f32 v248, v248, v67, v72
    v_max3_f32 v248, v248, v73, v74
    v_max_f32 v248, v248, v75
    v_max3_f32 v252, v68, v69, v70
    v_max3_f32 v252, v252, v71, v76
    v_max3_f32 v252, v252, v77, v78
    v_max_f32 v252, v252, v79
    v_mov_b32 v249, v248
    v_mov_b32 v253, v252
    s_nop 1
    v_permlane16_swap_b32 v248, v249
    v_permlane16_swap_b32 v252, v253
    s_nop 1
    v_max_f32 v248, v248, v249
    v_max_f32 v252, v252, v253
    v_mov_b32 v249, v248
    v_mov_b32 v253, v252
    s_nop 1
    v_permlane32_swap_b32 v248, v249
    v_permlane32_swap_b32 v252, v253
    s_nop 1
    v_max_f32 v248, v248, v249
    v_max_f32 v252, v252, v253
    v_max_f32 v248, 0, v248
    v_exp_f32 v249, -v248
    v_max_f32 v252, 0, v252
    v_exp_f32 v253, -v252
    v_sub_f32 v64, v64, v248
    v_sub_f32 v65, v65, v248
    v_sub_f32 v66, v66, v248
    v_sub_f32 v67, v67, v248
    v_sub_f32 v72, v72, v248
    v_sub_f32 v73, v73, v248
    v_sub_f32 v74, v74, v248
    v_sub_f32 v75, v75, v248
    v_sub_f32 v96, v96, v248
    v_sub_f32 v97, v97, v248
    v_sub_f32 v98, v98, v248
    v_sub_f32 v99, v99, v248
    v_sub_f32 v80, v80, v248
    v_sub_f32 v81, v81, v248
    v_sub_f32 v82, v82, v248
    v_sub_f32 v83, v83, v248
    v_sub_f32 v88, v88, v248
    v_sub_f32 v89, v89, v248
    v_sub_f32 v90, v90, v248
    v_sub_f32 v91, v91, v248
    v_mul_f32 v0, v0, v249
    v_mul_f32 v1, v1, v249
    v_mul_f32 v2, v2, v249
    v_mul_f32 v3, v3, v249
    v_mul_f32 v8, v8, v249
    v_mul_f32 v9, v9, v249
    v_mul_f32 v10, v10, v249
    v_mul_f32 v11, v11, v249
    v_mul_f32 v16, v16, v249
    v_mul_f32 v17, v17, v249
    v_mul_f32 v18, v18, v249
    v_mul_f32 v19, v19, v249
    v_mul_f32 v24, v24, v249
    v_mul_f32 v25, v25, v249
    v_mul_f32 v26, v26, v249
    v_mul_f32 v27, v27, v249
    v_mul_f32 v32, v32, v249
    v_mul_f32 v33, v33, v249
    v_mul_f32 v34, v34, v249
    v_mul_f32 v35, v35, v249
    v_mul_f32 v40, v40, v249
    v_mul_f32 v41, v41, v249
    v_mul_f32 v42, v42, v249
    v_mul_f32 v43, v43, v249
    v_mul_f32 v48, v48, v249
    v_mul_f32 v49, v49, v249
    v_mul_f32 v50, v50, v249
    v_mul_f32 v51, v51, v249
    v_mul_f32 v56, v56, v249
    v_mul_f32 v57, v57, v249
    v_mul_f32 v58, v58, v249
    v_mul_f32 v59, v59, v249
    v_mul_f32 v240, v240, v249
    v_mul_f32 v241, v241, v249
    v_sub_f32 v68, v68, v252
    v_sub_f32 v69, v69, v252
    v_sub_f32 v70, v70, v252
    v_sub_f32 v71, v71, v252
    v_sub_f32 v76, v76, v252
    v_sub_f32 v77, v77, v252
    v_sub_f32 v78, v78, v252
    v_sub_f32 v79, v79, v252
    v_sub_f32 v100, v100, v252
    v_sub_f32 v101, v101, v252
    v_sub_f32 v102, v102, v252
    v_sub_f32 v103, v103, v252
    v_sub_f32 v84, v84, v252
    v_sub_f32 v85, v85, v252
    v_sub_f32 v86, v86, v252
    v_sub_f32 v87, v87, v252
    v_sub_f32 v92, v92, v252
    v_sub_f32 v93, v93, v252
    v_sub_f32 v94, v94, v252
    v_sub_f32 v95, v95, v252
    v_mul_f32 v4, v4, v253
    v_mul_f32 v5, v5, v253
    v_mul_f32 v6, v6, v253
    v_mul_f32 v7, v7, v253
    v_mul_f32 v12, v12, v253
    v_mul_f32 v13, v13, v253
    v_mul_f32 v14, v14, v253
    v_mul_f32 v15, v15, v253
    v_mul_f32 v20, v20, v253
    v_mul_f32 v21, v21, v253
    v_mul_f32 v22, v22, v253
    v_mul_f32 v23, v23, v253
    v_mul_f32 v28, v28, v253
    v_mul_f32 v29, v29, v253
    v_mul_f32 v30, v30, v253
    v_mul_f32 v31, v31, v253
    v_mul_f32 v36, v36, v253
    v_mul_f32 v37, v37, v253
    v_mul_f32 v38, v38, v253
    v_mul_f32 v39, v39, v253
    v_mul_f32 v44, v44, v253
    v_mul_f32 v45, v45, v253
    v_mul_f32 v46, v46, v253
    v_mul_f32 v47, v47, v253
    v_mul_f32 v52, v52, v253
    v_mul_f32 v53, v53, v253
    v_mul_f32 v54, v54, v253
    v_mul_f32 v55, v55, v253
    v_mul_f32 v60, v60, v253
    v_mul_f32 v61, v61, v253
    v_mul_f32 v62, v62, v253
    v_mul_f32 v63, v63, v253
    v_mul_f32 v242, v242, v253
    v_mul_f32 v243, v243, v253
    v_exp_f32 v224, v64
    v_exp_f32 v225, v65
    v_exp_f32 v226, v66
    v_exp_f32 v227, v67
    v_cvt_pk_bf16_f32 v216, v224, v225
    v_pk_add_f32 v[244:245], v[224:225], v[226:227]
    v_cvt_pk_bf16_f32 v217, v226, v227
    v_exp_f32 v224, v72
    v_exp_f32 v225, v73
    v_exp_f32 v226, v74
    v_pk_add_f32 v[244:245], v[244:245], v[224:225]
    v_exp_f32 v227, v75
    v_cvt_pk_bf16_f32 v218, v224, v225
    v_pk_add_f32 v[244:245], v[244:245], v[226:227]
    v_cvt_pk_bf16_f32 v219, v226, v227
    v_exp_f32 v224, v68
    v_exp_f32 v225, v69
    v_exp_f32 v226, v70
    v_exp_f32 v227, v71
    v_cvt_pk_bf16_f32 v220, v224, v225
    v_pk_add_f32 v[246:247], v[224:225], v[226:227]
    v_cvt_pk_bf16_f32 v221, v226, v227
    v_exp_f32 v224, v76
    v_exp_f32 v225, v77
    v_exp_f32 v226, v78
    v_pk_add_f32 v[246:247], v[246:247], v[224:225]
    v_exp_f32 v227, v79
    v_cvt_pk_bf16_f32 v222, v224, v225
    v_pk_add_f32 v[246:247], v[246:247], v[226:227]
    v_cvt_pk_bf16_f32 v223, v226, v227
    s_nop 1
    s_branch L_slow3_ret
L_mask3:
    s_nop 7
    v_lshrrev_b32 v250, 4, v251
    v_lshlrev_b32 v250, 2, v250
    v_mov_b32 v248, 0xff800000
    v_add_u32 v249, 0, v250
    v_cmp_gt_u32 vcc, s12, v249
    s_nop 1
    v_cndmask_b32 v80, v248, v80, vcc
    v_cndmask_b32 v84, v248, v84, vcc
    v_add_u32 v249, 1, v250
    v_cmp_gt_u32 vcc, s12, v249
    s_nop 1
    v_cndmask_b32 v81, v248, v81, vcc
    v_cndmask_b32 v85, v248, v85, vcc
    v_add_u32 v249, 2, v250
    v_cmp_gt_u32 vcc, s12, v249
    s_nop 1
    v_cndmask_b32 v82, v248, v82, vcc
    v_cndmask_b32 v86, v248, v86, vcc
    v_add_u32 v249, 3, v250
    v_cmp_gt_u32 vcc, s12, v249
    s_nop 1
    v_cndmask_b32 v83, v248, v83, vcc
    v_cndmask_b32 v87, v248, v87, vcc
    v_add_u32 v249, 16, v250
    v_cmp_gt_u32 vcc, s12, v249
    s_nop 1
    v_cndmask_b32 v88, v248, v88, vcc
    v_cndmask_b32 v92, v248, v92, vcc
    v_add_u32 v249, 17, v250
    v_cmp_gt_u32 vcc, s12, v249
    s_nop 1
    v_cndmask_b32 v89, v248, v89, vcc
    v_cndmask_b32 v93, v248, v93, vcc
    v_add_u32 v249, 18, v250
    v_cmp_gt_u32 vcc, s12, v249
    s_nop 1
    v_cndmask_b32 v90, v248, v90, vcc
    v_cndmask_b32 v94, v248, v94, vcc
    v_add_u32 v249, 19, v250
    v_cmp_gt_u32 vcc, s12, v249
    s_nop 1
    v_cndmask_b32 v91, v248, v91, vcc
    v_cndmask_b32 v95, v248, v95, vcc
    s_branch L_mask3_ret
L_tick3:
    buffer_load_dword v254, off, s[40:43], s91 sc1
    s_mov_b32 s89, 0x7fffffff
    s_branch L_tick3_ret
L_bnd3:
    ds_read_b64_tr_b16 v[184:185], v232 offset:16384
    ds_read_b64_tr_b16 v[186:187], v232 offset:20480
    ds_read_b64_tr_b16 v[188:189], v233 offset:16384
    ds_read_b64_tr_b16 v[190:191], v233 offset:20480
    ds_read_b64_tr_b16 v[192:193], v234 offset:16384
    ds_read_b64_tr_b16 v[194:195], v234 offset:20480
    ds_read_b64_tr_b16 v[196:197], v235 offset:16384
    ds_read_b64_tr_b16 v[198:199], v235 offset:20480
    ds_read_b64_tr_b16 v[200:201], v236 offset:16384
    ds_read_b64_tr_b16 v[202:203], v236 offset:20480
    ds_read_b64_tr_b16 v[204:205], v237 offset:16384
    ds_read_b64_tr_b16 v[206:207], v237 offset:20480
    s_waitcnt lgkmcnt(8)
    ds_read_b64_tr_b16 v[208:209], v238 offset:16384
    ds_read_b64_tr_b16 v[210:211], v238 offset:20480
    ds_read_b64_tr_b16 v[212:213], v239 offset:16384
    ds_read_b64_tr_b16 v[214:215], v239 offset:20480
    s_branch L_last
L_slow4:
    s_nop 7
    v_max3_f32 v248, v80, v81, v82
    v_max3_f32 v248, v248, v83, v88
    v_max3_f32 v248, v248, v89, v90
    v_max_f32 v248, v248, v91
    v_max3_f32 v252, v84, v85, v86
    v_max3_f32 v252, v252, v87, v92
    v_max3_f32 v252, v252, v93, v94
    v_max_f32 v252, v252, v95
    v_mov_b32 v249, v248
    v_mov_b32 v253, v252
    s_nop 1
    v_permlane16_swap_b32 v248, v249
    v_permlane16_swap_b32 v252, v253
    s_nop 1
    v_max_f32 v248, v248, v249
    v_max_f32 v252, v252, v253
    v_mov_b32 v249, v248
    v_mov_b32 v253, v252
    s_nop 1
    v_permlane32_swap_b32 v248, v249
    v_permlane32_swap_b32 v252, v253
    s_nop 1
    v_max_f32 v248, v248, v249
    v_max_f32 v252, v252, v253
    v_max_f32 v248, 0, v248
    v_exp_f32 v249, -v248
    v_max_f32 v252, 0, v252
    v_exp_f32 v253, -v252
    v_sub_f32 v80, v80, v248
    v_sub_f32 v81, v81, v248
    v_sub_f32 v82, v82, v248
    v_sub_f32 v83, v83, v248
    v_sub_f32 v88, v88, v248
    v_sub_f32 v89, v89, v248
    v_sub_f32 v90, v90, v248
    v_sub_f32 v91, v91, v248
    v_sub_f32 v96, v96, v248
    v_sub_f32 v97, v97, v248
    v_sub_f32 v98, v98, v248
    v_sub_f32 v99, v99, v248
    v_sub_f32 v64, v64, v248
    v_sub_f32 v65, v65, v248
    v_sub_f32 v66, v66, v248
    v_sub_f32 v67, v67, v248
    v_sub_f32 v72, v72, v248
    v_sub_f32 v73, v73, v248
    v_sub_f32 v74, v74, v248
    v_sub_f32 v75, v75, v248
    v_mul_f32 v0, v0, v249
    v_mul_f32 v1, v1, v249
    v_mul_f32 v2, v2, v249
    v_mul_f32 v3, v3, v249
    v_mul_f32 v8, v8, v249
    v_mul_f32 v9, v9, v249
    v_mul_f32 v10, v10, v249
    v_mul_f32 v11, v11, v249
    v_mul_f32 v16, v16, v249
    v_mul_f32 v17, v17, v249
    v_mul_f32 v18, v18, v249
    v_mul_f32 v19, v19, v249
    v_mul_f32 v24, v24, v249
    v_mul_f32 v25, v25, v249
    v_mul_f32 v26, v26, v249
    v_mul_f32 v27, v27, v249
    v_mul_f32 v32, v32, v249
    v_mul_f32 v33, v33, v249
    v_mul_f32 v34, v34, v249
    v_mul_f32 v35, v35, v249
    v_mul_f32 v40, v40, v249
    v_mul_f32 v41, v41, v249
    v_mul_f32 v42, v42, v249
    v_mul_f32 v43, v43, v249
    v_mul_f32 v48, v48, v249
    v_mul_f32 v49, v49, v249
    v_mul_f32 v50, v50, v249
    v_mul_f32 v51, v51, v249
    v_mul_f32 v56, v56, v249
    v_mul_f32 v57, v57, v249
    v_mul_f32 v58, v58, v249
    v_mul_f32 v59, v59, v249
    v_mul_f32 v240, v240, v249
    v_mul_f32 v241, v241, v249
    v_sub_f32 v84, v84, v252
    v_sub_f32 v85, v85, v252
    v_sub_f32 v86, v86, v252
    v_sub_f32 v87, v87, v252
    v_sub_f32 v92, v92, v252
    v_sub_f32 v93, v93, v252
    v_sub_f32 v94, v94, v252
    v_sub_f32 v95, v95, v252
    v_sub_f32 v100, v100, v252
    v_sub_f32 v101, v101, v252
    v_sub_f32 v102, v102, v252
    v_sub_f32 v103, v103, v252
    v_sub_f32 v68, v68, v252
    v_sub_f32 v69, v69, v252
    v_sub_f32 v70, v70, v252
    v_sub_f32 v71, v71, v252
    v_sub_f32 v76, v76, v252
    v_sub_f32 v77, v77, v252
    v_sub_f32 v78, v78, v252
    v_sub_f32 v79, v79, v252
    v_mul_f32 v4, v4, v253
    v_mul_f32 v5, v5, v253
    v_mul_f32 v6, v6, v253
    v_mul_f32 v7, v7, v253
    v_mul_f32 v12, v12, v253
    v_mul_f32 v13, v13, v253
    v_mul_f32 v14, v14, v253
    v_mul_f32 v15, v15, v253
    v_mul_f32 v20, v20, v253
    v_mul_f32 v21, v21, v253
    v_mul_f32 v22, v22, v253
    v_mul_f32 v23, v23, v253
    v_mul_f32 v28, v28, v253
    v_mul_f32 v29, v29, v253
    v_mul_f32 v30, v30, v253
    v_mul_f32 v31, v31, v253
    v_mul_f32 v36, v36, v253
    v_mul_f32 v37, v37, v253
    v_mul_f32 v38, v38, v253
    v_mul_f32 v39, v39, v253
    v_mul_f32 v44, v44, v253
    v_mul_f32 v45, v45, v253
    v_mul_f32 v46, v46, v253
    v_mul_f32 v47, v47, v253
    v_mul_f32 v52, v52, v253
    v_mul_f32 v53, v53, v253
    v_mul_f32 v54, v54, v253
    v_mul_f32 v55, v55, v253
    v_mul_f32 v60, v60, v253
    v_mul_f32 v61, v61, v253
    v_mul_f32 v62, v62, v253
    v_mul_f32 v63, v63, v253
    v_mul_f32 v242, v242, v253
    v_mul_f32 v243, v243, v253
    v_exp_f32 v224, v80
    v_exp_f32 v225, v81
    v_exp_f32 v226, v82
    v_exp_f32 v227, v83
    v_cvt_pk_bf16_f32 v216, v224, v225
    v_pk_add_f32 v[244:245], v[224:225], v[226:227]
    v_cvt_pk_bf16_f32 v217, v226, v227
    v_exp_f32 v224, v88
    v_exp_f32 v225, v89
    v_exp_f32 v226, v90
    v_pk_add_f32 v[244:245], v[244:245], v[224:225]
    v_exp_f32 v227, v91
    v_cvt_pk_bf16_f32 v218, v224, v225
    v_pk_add_f32 v[244:245], v[244:245], v[226:227]
    v_cvt_pk_bf16_f32 v219, v226, v227
    v_exp_f32 v224, v84
    v_exp_f32 v225, v85
    v_exp_f32 v226, v86
    v_exp_f32 v227, v87
    v_cvt_pk_bf16_f32 v220, v224, v225
    v_pk_add_f32 v[246:247], v[224:225], v[226:227]
    v_cvt_pk_bf16_f32 v221, v226, v227
    v_exp_f32 v224, v92
    v_exp_f32 v225, v93
    v_exp_f32 v226, v94
    v_pk_add_f32 v[246:247], v[246:247], v[224:225]
    v_exp_f32 v227, v95
    v_cvt_pk_bf16_f32 v222, v224, v225
    v_pk_add_f32 v[246:247], v[246:247], v[226:227]
    v_cvt_pk_bf16_f32 v223, v226, v227
    s_nop 1
    s_branch L_slow4_ret
L_mask4:
    s_nop 7
    v_lshrrev_b32 v250, 4, v251
    v_lshlrev_b32 v250, 2, v250
    v_mov_b32 v248, 0xff800000
    v_add_u32 v249, 0, v250
    v_cmp_gt_u32 vcc, s12, v249
    s_nop 1
    v_cndmask_b32 v64, v248, v64, vcc
    v_cndmask_b32 v68, v248, v68, vcc
    v_add_u32 v249, 1, v250
    v_cmp_gt_u32 vcc, s12, v249
    s_nop 1
    v_cndmask_b32 v65, v248, v65, vcc
    v_cndmask_b32 v69, v248, v69, vcc
    v_add_u32 v249, 2, v250
    v_cmp_gt_u32 vcc, s12, v249
    s_nop 1
    v_cndmask_b32 v66, v248, v66, vcc
    v_cndmask_b32 v70, v248, v70, vcc
    v_add_u32 v249, 3, v250
    v_cmp_gt_u32 vcc, s12, v249
    s_nop 1
    v_cndmask_b32 v67, v248, v67, vcc
    v_cndmask_b32 v71, v248, v71, vcc
    v_add_u32 v249, 16, v250
    v_cmp_gt_u32 vcc, s12, v249
    s_nop 1
    v_cndmask_b32 v72, v248, v72, vcc
    v_cndmask_b32 v76, v248, v76, vcc
    v_add_u32 v249, 17, v250
    v_cmp_gt_u32 vcc, s12, v249
    s_nop 1
    v_cndmask_b32 v73, v248, v73, vcc
    v_cndmask_b32 v77, v248, v77, vcc
    v_add_u32 v249, 18, v250
    v_cmp_gt_u32 vcc, s12, v249
    s_nop 1
    v_cndmask_b32 v74, v248, v74, vcc
    v_cndmask_b32 v78, v248, v78, vcc
    v_add_u32 v249, 19, v250
    v_cmp_gt_u32 vcc, s12, v249
    s_nop 1
    v_cndmask_b32 v75, v248, v75, vcc
    v_cndmask_b32 v79, v248, v79, vcc
    s_branch L_mask4_ret
L_tick4:
    buffer_load_dword v254, off, s[40:43], s91 sc1
    s_mov_b32 s89, 0x7fffffff
    s_branch L_tick4_ret
L_bnd4:
    ds_read_b64_tr_b16 v[184:185], v232 offset:24576
    ds_read_b64_tr_b16 v[186:187], v232 offset:28672
    ds_read_b64_tr_b16 v[188:189], v233 offset:24576
    ds_read_b64_tr_b16 v[190:191], v233 offset:28672
    ds_read_b64_tr_b16 v[192:193], v234 offset:24576
    ds_read_b64_tr_b16 v[194:195], v234 offset:28672
    ds_read_b64_tr_b16 v[196:197], v235 offset:24576
    ds_read_b64_tr_b16 v[198:199], v235 offset:28672
    ds_read_b64_tr_b16 v[200:201], v236 offset:24576
    ds_read_b64_tr_b16 v[202:203], v236 offset:28672
    ds_read_b64_tr_b16 v[204:205], v237 offset:24576
    ds_read_b64_tr_b16 v[206:207], v237 offset:28672
    v_mov_b32 v64, v80
    v_mov_b32 v65, v81
    v_mov_b32 v66, v82
    v_mov_b32 v67, v83
    v_mov_b32 v68, v84
    v_mov_b32 v69, v85
    v_mov_b32 v70, v86
    v_mov_b32 v71, v87
    v_mov_b32 v72, v88
    v_mov_b32 v73, v89
    v_mov_b32 v74, v90
    v_mov_b32 v75, v91
    v_mov_b32 v76, v92
    v_mov_b32 v77, v93
    v_mov_b32 v78, v94
    v_mov_b32 v79, v95
    s_waitcnt lgkmcnt(8)
    ds_read_b64_tr_b16 v[208:209], v238 offset:24576
    ds_read_b64_tr_b16 v[210:211], v238 offset:28672
    ds_read_b64_tr_b16 v[212:213], v239 offset:24576
    ds_read_b64_tr_b16 v[214:215], v239 offset:28672
    s_branch L_last
L_slow5:
    s_nop 7
    v_max3_f32 v248, v64, v65, v66
    v_max3_f32 v248, v248, v67, v72
    v_max3_f32 v248, v248, v73, v74
    v_max_f32 v248, v248, v75
    v_max3_f32 v252, v68, v69, v70
    v_max3_f32 v252, v252, v71, v76
    v_max3_f32 v252, v252, v77, v78
    v_max_f32 v252, v252, v79
    v_mov_b32 v249, v248
    v_mov_b32 v253, v252
    s_nop 1
    v_permlane16_swap_b32 v248, v249
    v_permlane16_swap_b32 v252, v253
    s_nop 1
    v_max_f32 v248, v248, v249
    v_max_f32 v252, v252, v253
    v_mov_b32 v249, v248
    v_mov_b32 v253, v252
    s_nop 1
    v_permlane32_swap_b32 v248, v249
    v_permlane32_swap_b32 v252, v253
    s_nop 1
    v_max_f32 v248, v248, v249
    v_max_f32 v252, v252, v253
    v_max_f32 v248, 0, v248
    v_exp_f32 v249, -v248
    v_max_f32 v252, 0, v252
    v_exp_f32 v253, -v252
    v_sub_f32 v64, v64, v248
    v_sub_f32 v65, v65, v248
    v_sub_f32 v66, v66, v248
    v_sub_f32 v67, v67, v248
    v_sub_f32 v72, v72, v248
    v_sub_f32 v73, v73, v248
    v_sub_f32 v74, v74, v248
    v_sub_f32 v75, v75, v248
    v_sub_f32 v96, v96, v248
    v_sub_f32 v97, v97, v248
    v_sub_f32 v98, v98, v248
    v_sub_f32 v99, v99, v248
    v_sub_f32 v80, v80, v248
    v_sub_f32 v81, v81, v248
    v_sub_f32 v82, v82, v248
    v_sub_f32 v83, v83, v248
    v_sub_f32 v88, v88, v248
    v_sub_f32 v89, v89, v248
    v_sub_f32 v90, v90, v248
    v_sub_f32 v91, v91, v248
    v_mul_f32 v0, v0, v249
    v_mul_f32 v1, v1, v249
    v_mul_f32 v2, v2, v249
    v_mul_f32 v3, v3, v249
    v_mul_f32 v8, v8, v249
    v_mul_f32 v9, v9, v249
    v_mul_f32 v10, v10, v249
    v_mul_f32 v11, v11, v249
    v_mul_f32 v16, v16, v249
    v_mul_f32 v17, v17, v249
    v_mul_f32 v18, v18, v249
    v_mul_f32 v19, v19, v249
    v_mul_f32 v24, v24, v249
    v_mul_f32 v25, v25, v249
    v_mul_f32 v26, v26, v249
    v_mul_f32 v27, v27, v249
    v_mul_f32 v32, v32, v249
    v_mul_f32 v33, v33, v249
    v_mul_f32 v34, v34, v249
    v_mul_f32 v35, v35, v249
    v_mul_f32 v40, v40, v249
    v_mul_f32 v41, v41, v249
    v_mul_f32 v42, v42, v249
    v_mul_f32 v43, v43, v249
    v_mul_f32 v48, v48, v249
    v_mul_f32 v49, v49, v249
    v_mul_f32 v50, v50, v249
    v_mul_f32 v51, v51, v249
    v_mul_f32 v56, v56, v249
    v_mul_f32 v57, v57, v249
    v_mul_f32 v58, v58, v249
    v_mul_f32 v59, v59, v249
    v_mul_f32 v240, v240, v249
    v_mul_f32 v241, v241, v249
    v_sub_f32 v68, v68, v252
    v_sub_f32 v69, v69, v252
    v_sub_f32 v70, v70, v252
    v_sub_f32 v71, v71, v252
    v_sub_f32 v76, v76, v252
    v_sub_f32 v77, v77, v252
    v_sub_f32 v78, v78, v252
    v_sub_f32 v79, v79, v252
    v_sub_f32 v100, v100, v252
    v_sub_f32 v101, v101, v252
    v_sub_f32 v102, v102, v252
    v_sub_f32 v103, v103, v252
    v_sub_f32 v84, v84, v252
    v_sub_f32 v85, v85, v252
    v_sub_f32 v86, v86, v252
    v_sub_f32 v87, v87, v252
    v_sub_f32 v92, v92, v252
    v_sub_f32 v93, v93, v252
    v_sub_f32 v94, v94, v252
    v_sub_f32 v95, v95, v252
    v_mul_f32 v4, v4, v253
    v_mul_f32 v5, v5, v253
    v_mul_f32 v6, v6, v253
    v_mul_f32 v7, v7, v253
    v_mul_f32 v12, v12, v253
    v_mul_f32 v13, v13, v253
    v_mul_f32 v14, v14, v253
    v_mul_f32 v15, v15, v253
    v_mul_f32 v20, v20, v253
    v_mul_f32 v21, v21, v253
    v_mul_f32 v22, v22, v253
    v_mul_f32 v23, v23, v253
    v_mul_f32 v28, v28, v253
    v_mul_f32 v29, v29, v253
    v_mul_f32 v30, v30, v253
    v_mul_f32 v31, v31, v253
    v_mul_f32 v36, v36, v253
    v_mul_f32 v37, v37, v253
    v_mul_f32 v38, v38, v253
    v_mul_f32 v39, v39, v253
    v_mul_f32 v44, v44, v253
    v_mul_f32 v45, v45, v253
    v_mul_f32 v46, v46, v253
    v_mul_f32 v47, v47, v253
    v_mul_f32 v52, v52, v253
    v_mul_f32 v53, v53, v253
    v_mul_f32 v54, v54, v253
    v_mul_f32 v55, v55, v253
    v_mul_f32 v60, v60, v253
    v_mul_f32 v61, v61, v253
    v_mul_f32 v62, v62, v253
    v_mul_f32 v63, v63, v253
    v_mul_f32 v242, v242, v253
    v_mul_f32 v243, v243, v253
    v_exp_f32 v224, v64
    v_exp_f32 v225, v65
    v_exp_f32 v226, v66
    v_exp_f32 v227, v67
    v_cvt_pk_bf16_f32 v216, v224, v225
    v_pk_add_f32 v[244:245], v[224:225], v[226:227]
    v_cvt_pk_bf16_f32 v217, v226, v227
    v_exp_f32 v224, v72
    v_exp_f32 v225, v73
    v_exp_f32 v226, v74
    v_pk_add_f32 v[244:245], v[244:245], v[224:225]
    v_exp_f32 v227, v75
    v_cvt_pk_bf16_f32 v218, v224, v225
    v_pk_add_f32 v[244:245], v[244:245], v[226:227]
    v_cvt_pk_bf16_f32 v219, v226, v227
    v_exp_f32 v224, v68
    v_exp_f32 v225, v69
    v_exp_f32 v226, v70
    v_exp_f32 v227, v71
    v_cvt_pk_bf16_f32 v220, v224, v225
    v_pk_add_f32 v[246:247], v[224:225], v[226:227]
    v_cvt_pk_bf16_f32 v221, v226, v227
    v_exp_f32 v224, v76
    v_exp_f32 v225, v77
    v_exp_f32 v226, v78
    v_pk_add_f32 v[246:247], v[246:247], v[224:225]
    v_exp_f32 v227, v79
    v_cvt_pk_bf16_f32 v222, v224, v225
    v_pk_add_f32 v[246:247], v[246:247], v[226:227]
    v_cvt_pk_bf16_f32 v223, v226, v227
    s_nop 1
    s_branch L_slow5_ret
L_mask5:
    s_nop 7
    v_lshrrev_b32 v250, 4, v251
    v_lshlrev_b32 v250, 2, v250
    v_mov_b32 v248, 0xff800000
    v_add_u32 v249, 0, v250
    v_cmp_gt_u32 vcc, s12, v249
    s_nop 1
    v_cndmask_b32 v80, v248, v80, vcc
    v_cndmask_b32 v84, v248, v84, vcc
    v_add_u32 v249, 1, v250
    v_cmp_gt_u32 vcc, s12, v249
    s_nop 1
    v_cndmask_b32 v81, v248, v81, vcc
    v_cndmask_b32 v85, v248, v85, vcc
    v_add_u32 v249, 2, v250
    v_cmp_gt_u32 vcc, s12, v249
    s_nop 1
    v_cndmask_b32 v82, v248, v82, vcc
    v_cndmask_b32 v86, v248, v86, vcc
    v_add_u32 v249, 3, v250
    v_cmp_gt_u32 vcc, s12, v249
    s_nop 1
    v_cndmask_b32 v83, v248, v83, vcc
    v_cndmask_b32 v87, v248, v87, vcc
    v_add_u32 v249, 16, v250
    v_cmp_gt_u32 vcc, s12, v249
    s_nop 1
    v_cndmask_b32 v88, v248, v88, vcc
    v_cndmask_b32 v92, v248, v92, vcc
    v_add_u32 v249, 17, v250
    v_cmp_gt_u32 vcc, s12, v249
    s_nop 1
    v_cndmask_b32 v89, v248, v89, vcc
    v_cndmask_b32 v93, v248, v93, vcc
    v_add_u32 v249, 18, v250
    v_cmp_gt_u32 vcc, s12, v249
    s_nop 1
    v_cndmask_b32 v90, v248, v90, vcc
    v_cndmask_b32 v94, v248, v94, vcc
    v_add_u32 v249, 19, v250
    v_cmp_gt_u32 vcc, s12, v249
    s_nop 1
    v_cndmask_b32 v91, v248, v91, vcc
    v_cndmask_b32 v95, v248, v95, vcc
    s_branch L_mask5_ret
L_tick5:
    buffer_load_dword v254, off, s[40:43], s91 sc1
    s_mov_b32 s89, 0x7fffffff
    s_branch L_tick5_ret
L_bnd5:
    ds_read_b64_tr_b16 v[184:185], v232 offset:32768
    ds_read_b64_tr_b16 v[186:187], v232 offset:36864
    ds_read_b64_tr_b16 v[188:189], v233 offset:32768
    ds_read_b64_tr_b16 v[190:191], v233 offset:36864
    ds_read_b64_tr_b16 v[192:193], v234 offset:32768
    ds_read_b64_tr_b16 v[194:195], v234 offset:36864
    ds_read_b64_tr_b16 v[196:197], v235 offset:32768
    ds_read_b64_tr_b16 v[198:199], v235 offset:36864
    ds_read_b64_tr_b16 v[200:201], v236 offset:32768
    ds_read_b64_tr_b16 v[202:203], v236 offset:36864
    ds_read_b64_tr_b16 v[204:205], v237 offset:32768
    ds_read_b64_tr_b16 v[206:207], v237 offset:36864
    s_waitcnt lgkmcnt(8)
    ds_read_b64_tr_b16 v[208:209], v238 offset:32768
    ds_read_b64_tr_b16 v[210:211], v238 offset:36864
    ds_read_b64_tr_b16 v[212:213], v239 offset:32768
    ds_read_b64_tr_b16 v[214:215], v239 offset:36864
    s_branch L_last
L_last:
    v_exp_f32 v224, v68
    v_exp_f32 v225, v69
    v_exp_f32 v226, v70
    v_exp_f32 v227, v71
    v_cvt_pk_bf16_f32 v220, v224, v225
    v_pk_add_f32 v[246:247], v[224:225], v[226:227]
    v_cvt_pk_bf16_f32 v221, v226, v227
    v_exp_f32 v224, v76
    v_exp_f32 v225, v77
    v_exp_f32 v226, v78
    v_pk_add_f32 v[246:247], v[246:247], v[224:225]
    v_exp_f32 v227, v79
    v_cvt_pk_bf16_f32 v222, v224, v225
    v_pk_add_f32 v[246:247], v[246:247], v[226:227]
    v_cvt_pk_bf16_f32 v223, v226, v227
    v_max3_f32 v248, v244, v245, v246
    v_max_f32 v248, v248, v247
    v_cmp_lt_f32 vcc, s15, v248
    s_nop 1
    s_cbranch_vccz L_last_ok
    s_nop 7
    v_max3_f32 v248, v64, v65, v66
    v_max3_f32 v248, v248, v67, v72
    v_max3_f32 v248, v248, v73, v74
    v_max_f32 v248, v248, v75
    v_max3_f32 v252, v68, v69, v70
    v_max3_f32 v252, v252, v71, v76
    v_max3_f32 v252, v252, v77, v78
    v_max_f32 v252, v252, v79
    v_mov_b32 v249, v248
    v_mov_b32 v253, v252
    s_nop 1
    v_permlane16_swap_b32 v248, v249
    v_permlane16_swap_b32 v252, v253
    s_nop 1
    v_max_f32 v248, v248, v249
    v_max_f32 v252, v252, v253
    v_mov_b32 v249, v248
    v_mov_b32 v253, v252
    s_nop 1
    v_permlane32_swap_b32 v248, v249
    v_permlane32_swap_b32 v252, v253
    s_nop 1
    v_max_f32 v248, v248, v249
    v_max_f32 v252, v252, v253
    v_max_f32 v248, 0, v248
    v_exp_f32 v249, -v248
    v_max_f32 v252, 0, v252
    v_exp_f32 v253, -v252
    v_sub_f32 v64, v64, v248
    v_sub_f32 v65, v65, v248
    v_sub_f32 v66, v66, v248
    v_sub_f32 v67, v67, v248
    v_sub_f32 v72, v72, v248
    v_sub_f32 v73, v73, v248
    v_sub_f32 v74, v74, v248
    v_sub_f32 v75, v75, v248
    v_sub_f32 v96, v96, v248
    v_sub_f32 v97, v97, v248
    v_sub_f32 v98, v98, v248
    v_sub_f32 v99, v99, v248
    v_mul_f32 v0, v0, v249
    v_mul_f32 v1, v1, v249
    v_mul_f32 v2, v2, v249
    v_mul_f32 v3, v3, v249
    v_mul_f32 v8, v8, v249
    v_mul_f32 v9, v9, v249
    v_mul_f32 v10, v10, v249
    v_mul_f32 v11, v11, v249
    v_mul_f32 v16, v16, v249
    v_mul_f32 v17, v17, v249
    v_mul_f32 v18, v18, v249
    v_mul_f32 v19, v19, v249
    v_mul_f32 v24, v24, v249
    v_mul_f32 v25, v25, v249
    v_mul_f32 v26, v26, v249
    v_mul_f32 v27, v27, v249
    v_mul_f32 v32, v32, v249
    v_mul_f32 v33, v33, v249
    v_mul_f32 v34, v34, v249
    v_mul_f32 v35, v35, v249
    v_mul_f32 v40, v40, v249
    v_mul_f32 v41, v41, v249
    v_mul_f32 v42, v42, v249
    v_mul_f32 v43, v43, v249
    v_mul_f32 v48, v48, v249
    v_mul_f32 v49, v49, v249
    v_mul_f32 v50, v50, v249
    v_mul_f32 v51, v51, v249
    v_mul_f32 v56, v56, v249
    v_mul_f32 v57, v57, v249
    v_mul_f32 v58, v58, v249
    v_mul_f32 v59, v59, v249
    v_mul_f32 v240, v240, v249
    v_mul_f32 v241, v241, v249
    v_sub_f32 v68, v68, v252
    v_sub_f32 v69, v69, v252
    v_sub_f32 v70, v70, v252
    v_sub_f32 v71, v71, v252
    v_sub_f32 v76, v76, v252
    v_sub_f32 v77, v77, v252
    v_sub_f32 v78, v78, v252
    v_sub_f32 v79, v79, v252
    v_sub_f32 v100, v100, v252
    v_sub_f32 v101, v101, v252
    v_sub_f32 v102, v102, v252
    v_sub_f32 v103, v103, v252
    v_mul_f32 v4, v4, v253
    v_mul_f32 v5, v5, v253
    v_mul_f32 v6, v6, v253
    v_mul_f32 v7, v7, v253
    v_mul_f32 v12, v12, v253
    v_mul_f32 v13, v13, v253
    v_mul_f32 v14, v14, v253
    v_mul_f32 v15, v15, v253
    v_mul_f32 v20, v20, v253
    v_mul_f32 v21, v21, v253
    v_mul_f32 v22, v22, v253
    v_mul_f32 v23, v23, v253
    v_mul_f32 v28, v28, v253
    v_mul_f32 v29, v29, v253
    v_mul_f32 v30, v30, v253
    v_mul_f32 v31, v31, v253
    v_mul_f32 v36, v36, v253
    v_mul_f32 v37, v37, v253
    v_mul_f32 v38, v38, v253
    v_mul_f32 v39, v39, v253
    v_mul_f32 v44, v44, v253
    v_mul_f32 v45, v45, v253
    v_mul_f32 v46, v46, v253
    v_mul_f32 v47, v47, v253
    v_mul_f32 v52, v52, v253
    v_mul_f32 v53, v53, v253
    v_mul_f32 v54, v54, v253
    v_mul_f32 v55, v55, v253
    v_mul_f32 v60, v60, v253
    v_mul_f32 v61, v61, v253
    v_mul_f32 v62, v62, v253
    v_mul_f32 v63, v63, v253
    v_mul_f32 v242, v242, v253
    v_mul_f32 v243, v243, v253
    v_exp_f32 v224, v64
    v_exp_f32 v225, v65
    v_exp_f32 v226, v66
    v_exp_f32 v227, v67
    v_cvt_pk_bf16_f32 v216, v224, v225
    v_pk_add_f32 v[244:245], v[224:225], v[226:227]
    v_cvt_pk_bf16_f32 v217, v226, v227
    v_exp_f32 v224, v72
    v_exp_f32 v225, v73
    v_exp_f32 v226, v74
    v_pk_add_f32 v[244:245], v[244:245], v[224:225]
    v_exp_f32 v227, v75
    v_cvt_pk_bf16_f32 v218, v224, v225
    v_pk_add_f32 v[244:245], v[244:245], v[226:227]
    v_cvt_pk_bf16_f32 v219, v226, v227
    v_exp_f32 v224, v68
    v_exp_f32 v225, v69
    v_exp_f32 v226, v70
    v_exp_f32 v227, v71
    v_cvt_pk_bf16_f32 v220, v224, v225
    v_pk_add_f32 v[246:247], v[224:225], v[226:227]
    v_cvt_pk_bf16_f32 v221, v226, v227
    v_exp_f32 v224, v76
    v_exp_f32 v225, v77
    v_exp_f32 v226, v78
    v_pk_add_f32 v[246:247], v[246:247], v[224:225]
    v_exp_f32 v227, v79
    v_cvt_pk_bf16_f32 v222, v224, v225
    v_pk_add_f32 v[246:247], v[246:247], v[226:227]
    v_cvt_pk_bf16_f32 v223, v226, v227
    s_nop 1
L_last_ok:
    v_pk_add_f32 v[240:241], v[240:241], v[244:245]
    v_pk_add_f32 v[242:243], v[242:243], v[246:247]
    s_waitcnt lgkmcnt(0)
    v_mfma_f32_16x16x32_bf16 v[0:3], v[184:187], v[216:219], v[0:3]
    v_mfma_f32_16x16x32_bf16 v[8:11], v[188:191], v[216:219], v[8:11]
    v_mfma_f32_16x16x32_bf16 v[16:19], v[192:195], v[216:219], v[16:19]
    v_mfma_f32_16x16x32_bf16 v[24:27], v[196:199], v[216:219], v[24:27]
    v_mfma_f32_16x16x32_bf16 v[32:35], v[200:203], v[216:219], v[32:35]
    v_mfma_f32_16x16x32_bf16 v[40:43], v[204:207], v[216:219], v[40:43]
    v_mfma_f32_16x16x32_bf16 v[48:51], v[208:211], v[216:219], v[48:51]
    v_mfma_f32_16x16x32_bf16 v[56:59], v[212:215], v[216:219], v[56:59]
    v_mfma_f32_16x16x32_bf16 v[4:7], v[184:187], v[220:223], v[4:7]
    v_mfma_f32_16x16x32_bf16 v[12:15], v[188:191], v[220:223], v[12:15]
    v_mfma_f32_16x16x32_bf16 v[20:23], v[192:195], v[220:223], v[20:23]
    v_mfma_f32_16x16x32_bf16 v[28:31], v[196:199], v[220:223], v[28:31]
    v_mfma_f32_16x16x32_bf16 v[36:39], v[200:203], v[220:223], v[36:39]
    v_mfma_f32_16x16x32_bf16 v[44:47], v[204:207], v[220:223], v[44:47]
    v_mfma_f32_16x16x32_bf16 v[52:55], v[208:211], v[220:223], v[52:55]
    v_mfma_f32_16x16x32_bf16 v[60:63], v[212:215], v[220:223], v[60:63]
    v_add_f32 v248, v240, v241
    v_add_f32 v252, v242, v243
    v_mov_b32 v249, v248
    v_mov_b32 v253, v252
    s_nop 1
    v_permlane16_swap_b32 v248, v249
    v_permlane16_swap_b32 v252, v253
    s_nop 1
    v_add_f32 v248, v248, v249
    v_add_f32 v252, v252, v253
    v_mov_b32 v249, v248
    v_mov_b32 v253, v252
    s_nop 1
    v_permlane32_swap_b32 v248, v249
    v_permlane32_swap_b32 v252, v253
    s_nop 1
    v_add_f32 v248, v248, v249
    v_add_f32 v252, v252, v253
    s_add_u32 s90, s97, s5
    s_add_u32 s90, s90, s14
    s_lshl_b32 s90, s90, 2
    s_add_u32 s90, s90, s6
    s_lshl_b32 s90, s90, 6
    s_add_u32 s90, s90, 14680064
    s_waitcnt vmcnt(0)
    s_cmp_lt_u32 s9, s8
    s_cbranch_scc0 L_fin
    s_mov_b32 m0, s14
    s_nop 0
    s_movrels_b32 s32, s76
    s_cmp_lt_u32 s32, s7
    s_cbranch_scc0 L_out
    s_mul_i32 s32, s6, 8704
    s_add_u32 s32, s32, 98304
    v_and_b32 v250, 16, v251
    v_cmp_eq_u32 vcc, 0, v250
    v_lshl_add_u32 v250, v251, 3, s32
    v_lshl_add_u32 v224, v251, 4, s32
    v_cndmask_b32 v249, v252, v248, vcc
    v_cndmask_b32 v248, v100, v96, vcc
    v_sub_f32 v248, 0, v248
    ds_write_b64 v250, v[248:249] offset:8192
    v_cvt_pk_bf16_f32 v184, v0, v1
    v_cvt_pk_bf16_f32 v185, v2, v3
    v_cvt_pk_bf16_f32 v186, v8, v9
    v_cvt_pk_bf16_f32 v187, v10, v11
    ds_write_b128 v224, v[184:187] offset:0
    v_cvt_pk_bf16_f32 v188, v16, v17
    v_cvt_pk_bf16_f32 v189, v18, v19
    v_cvt_pk_bf16_f32 v190, v24, v25
    v_cvt_pk_bf16_f32 v191, v26, v27
    ds_write_b128 v224, v[188:191] offset:1024
    v_cvt_pk_bf16_f32 v192, v32, v33
    v_cvt_pk_bf16_f32 v193, v34, v35
    v_cvt_pk_bf16_f32 v194, v40, v41
    v_cvt_pk_bf16_f32 v195, v42, v43
    ds_write_b128 v224, v[192:195] offset:2048
    v_cvt_pk_bf16_f32 v196, v48, v49
    v_cvt_pk_bf16_f32 v197, v50, v51
    v_cvt_pk_bf16_f32 v198, v56, v57
    v_cvt_pk_bf16_f32 v199, v58, v59
    ds_write_b128 v224, v[196:199] offset:3072
    v_cvt_pk_bf16_f32 v200, v4, v5
    v_cvt_pk_bf16_f32 v201, v6, v7
    v_cvt_pk_bf16_f32 v202, v12, v13
    v_cvt_pk_bf16_f32 v203, v14, v15
    ds_write_b128 v224, v[200:203] offset:4096
    v_cvt_pk_bf16_f32 v204, v20, v21
    v_cvt_pk_bf16_f32 v205, v22, v23
    v_cvt_pk_bf16_f32 v206, v28, v29
    v_cvt_pk_bf16_f32 v207, v30, v31
    ds_write_b128 v224, v[204:207] offset:5120
    v_cvt_pk_bf16_f32 v208, v36, v37
    v_cvt_pk_bf16_f32 v209, v38, v39
    v_cvt_pk_bf16_f32 v210, v44, v45
    v_cvt_pk_bf16_f32 v211, v46, v47
    ds_write_b128 v224, v[208:211] offset:6144
    v_cvt_pk_bf16_f32 v212, v52, v53
    v_cvt_pk_bf16_f32 v213, v54, v55
    v_cvt_pk_bf16_f32 v214, v60, v61
    v_cvt_pk_bf16_f32 v215, v62, v63
    ds_write_b128 v224, v[212:215] offset:7168
    s_branch L_next
L_fin:
    s_cmp_eq_u32 s88, 0
    s_cbranch_scc1 L_merge
L_part:
    v_and_b32 v250, 16, v251
    v_cmp_eq_u32 vcc, 0, v250
    s_add_u32 s32, s5, s14
    s_mul_i32 s33, s4, 44
    s_add_u32 s32, s32, s33
    v_cndmask_b32 v249, v252, v248, vcc
    v_cndmask_b32 v248, v100, v96, vcc
    s_lshl_b32 s32, s32, 2
    s_add_u32 s32, s32, s6
    v_sub_f32 v248, 0, v248
    s_lshl_b32 s33, s32, 9
    s_add_u32 s33, s33, 11534336
    v_lshlrev_b32 v250, 3, v251
    s_lshl_b32 s32, s32, 13
    buffer_store_dwordx2 v[248:249], v250, s[48:51], s33 offen sc1
    s_add_u32 s33, s32, 4096
    v_lshlrev_b32 v252, 4, v251
    v_cvt_pk_bf16_f32 v184, v0, v1
    v_cvt_pk_bf16_f32 v185, v2, v3
    v_cvt_pk_bf16_f32 v186, v8, v9
    v_cvt_pk_bf16_f32 v187, v10, v11
    buffer_store_dwordx4 v[184:187], v252, s[48:51], s32 offen offset:0 sc1
    v_cvt_pk_bf16_f32 v188, v16, v17
    v_cvt_pk_bf16_f32 v189, v18, v19
    v_cvt_pk_bf16_f32 v190, v24, v25
    v_cvt_pk_bf16_f32 v191, v26, v27
    buffer_store_dwordx4 v[188:191], v252, s[48:51], s32 offen offset:1024 sc1
    v_cvt_pk_bf16_f32 v192, v32, v33
    v_cvt_pk_bf16_f32 v193, v34, v35
    v_cvt_pk_bf16_f32 v194, v40, v41
    v_cvt_pk_bf16_f32 v195, v42, v43
    buffer_store_dwordx4 v[192:195], v252, s[48:51], s32 offen offset:2048 sc1
    v_cvt_pk_bf16_f32 v196, v48, v49
    v_cvt_pk_bf16_f32 v197, v50, v51
    v_cvt_pk_bf16_f32 v198, v56, v57
    v_cvt_pk_bf16_f32 v199, v58, v59
    buffer_store_dwordx4 v[196:199], v252, s[48:51], s32 offen offset:3072 sc1
    v_cvt_pk_bf16_f32 v200, v4, v5
    v_cvt_pk_bf16_f32 v201, v6, v7
    v_cvt_pk_bf16_f32 v202, v12, v13
    v_cvt_pk_bf16_f32 v203, v14, v15
    buffer_store_dwordx4 v[200:203], v252, s[48:51], s33 offen offset:0 sc1
    v_cvt_pk_bf16_f32 v204, v20, v21
    v_cvt_pk_bf16_f32 v205, v22, v23
    v_cvt_pk_bf16_f32 v206, v28, v29
    v_cvt_pk_bf16_f32 v207, v30, v31
    buffer_store_dwordx4 v[204:207], v252, s[48:51], s33 offen offset:1024 sc1
    v_cvt_pk_bf16_f32 v208, v36, v37
    v_cvt_pk_bf16_f32 v209, v38, v39
    v_cvt_pk_bf16_f32 v210, v44, v45
    v_cvt_pk_bf16_f32 v211, v46, v47
    buffer_store_dwordx4 v[208:211], v252, s[48:51], s33 offen offset:2048 sc1
    v_cvt_pk_bf16_f32 v212, v52, v53
    v_cvt_pk_bf16_f32 v213, v54, v55
    v_cvt_pk_bf16_f32 v214, v60, v61
    v_cvt_pk_bf16_f32 v215, v62, v63
    buffer_store_dwordx4 v[212:215], v252, s[48:51], s33 offen offset:3072 sc1
    s_cmp_ge_u32 s9, s8
    s_cbranch_scc1 L_pdone
L_next:
    s_add_u32 s14, s14, 1
    s_mov_b32 m0, s14
    s_nop 0
    s_movrels_b32 s12, s68
    s_movrels_b32 s11, s77
    s_movrels_b32 s13, s56
    s_sub_u32 s11, s11, s7
    s_min_u32 s10, s11, s8
    s_sub_u32 s11, s11, 1
    s_sub_u32 s12, s12, 1
    s_and_b32 s12, s12, 31
    s_add_u32 s12, s12, 1
    s_cmp_gt_i32 s13, 0
    s_cselect_b32 s13, 0x3e0293ee, 0
    v_lshlrev_b32 v224, 16, v136
    v_and_b32 v225, 0xffff0000, v136
    v_mul_f32 v224, s13, v224
    v_mul_f32 v225, s13, v225
    v_cvt_pk_bf16_f32 v104, v224, v225
    v_lshlrev_b32 v226, 16, v137
    v_and_b32 v227, 0xffff0000, v137
    v_mul_f32 v226, s13, v226
    v_mul_f32 v227, s13, v227
    v_cvt_pk_bf16_f32 v105, v226, v227
    v_lshlrev_b32 v224, 16, v138
    v_and_b32 v225, 0xffff0000, v138
    v_mul_f32 v224, s13, v224
    v_mul_f32 v225, s13, v225
    v_cvt_pk_bf16_f32 v106, v224, v225
    v_lshlrev_b32 v226, 16, v139
    v_and_b32 v227, 0xffff0000, v139
    v_mul_f32 v226, s13, v226
    v_mul_f32 v227, s13, v227
    v_cvt_pk_bf16_f32 v107, v226, v227
    v_lshlrev_b32 v224, 16, v140
    v_and_b32 v225, 0xffff0000, v140
    v_mul_f32 v224, s13, v224
    v_mul_f32 v225, s13, v225
    v_cvt_pk_bf16_f32 v108, v224, v225
    v_lshlrev_b32 v226, 16, v141
    v_and_b32 v227, 0xffff0000, v141
    v_mul_f32 v226, s13, v226
    v_mul_f32 v227, s13, v227
    v_cvt_pk_bf16_f32 v109, v226, v227
    v_lshlrev_b32 v224, 16, v142
    v_and_b32 v225, 0xffff0000, v142
    v_mul_f32 v224, s13, v224
    v_mul_f32 v225, s13, v225
    v_cvt_pk_bf16_f32 v110, v224, v225
    v_lshlrev_b32 v226, 16, v143
    v_and_b32 v227, 0xffff0000, v143
    v_mul_f32 v226, s13, v226
    v_mul_f32 v227, s13, v227
    v_cvt_pk_bf16_f32 v111, v226, v227
    v_lshlrev_b32 v224, 16, v144
    v_and_b32 v225, 0xffff0000, v144
    v_mul_f32 v224, s13, v224
    v_mul_f32 v225, s13, v225
    v_cvt_pk_bf16_f32 v112, v224, v225
    v_lshlrev_b32 v226, 16, v145
    v_and_b32 v227, 0xffff0000, v145
    v_mul_f32 v226, s13, v226
    v_mul_f32 v227, s13, v227
    v_cvt_pk_bf16_f32 v113, v226, v227
    v_lshlrev_b32 v224, 16, v146
    v_and_b32 v225, 0xffff0000, v146
    v_mul_f32 v224, s13, v224
    v_mul_f32 v225, s13, v225
    v_cvt_pk_bf16_f32 v114, v224, v225
    v_lshlrev_b32 v226, 16, v147
    v_and_b32 v227, 0xffff0000, v147
    v_mul_f32 v226, s13, v226
    v_mul_f32 v227, s13, v227
    v_cvt_pk_bf16_f32 v115, v226, v227
    v_lshlrev_b32 v224, 16, v148
    v_and_b32 v225, 0xffff0000, v148
    v_mul_f32 v224, s13, v224
    v_mul_f32 v225, s13, v225
    v_cvt_pk_bf16_f32 v116, v224, v225
    v_lshlrev_b32 v226, 16, v149
    v_and_b32 v227, 0xffff0000, v149
    v_mul_f32 v226, s13, v226
    v_mul_f32 v227, s13, v227
    v_cvt_pk_bf16_f32 v117, v226, v227
    v_lshlrev_b32 v224, 16, v150
    v_and_b32 v225, 0xffff0000, v150
    v_mul_f32 v224, s13, v224
    v_mul_f32 v225, s13, v225
    v_cvt_pk_bf16_f32 v118, v224, v225
    v_lshlrev_b32 v226, 16, v151
    v_and_b32 v227, 0xffff0000, v151
    v_mul_f32 v226, s13, v226
    v_mul_f32 v227, s13, v227
    v_cvt_pk_bf16_f32 v119, v226, v227
    v_lshlrev_b32 v224, 16, v152
    v_and_b32 v225, 0xffff0000, v152
    v_mul_f32 v224, s13, v224
    v_mul_f32 v225, s13, v225
    v_cvt_pk_bf16_f32 v120, v224, v225
    v_lshlrev_b32 v226, 16, v153
    v_and_b32 v227, 0xffff0000, v153
    v_mul_f32 v226, s13, v226
    v_mul_f32 v227, s13, v227
    v_cvt_pk_bf16_f32 v121, v226, v227
    v_lshlrev_b32 v224, 16, v154
    v_and_b32 v225, 0xffff0000, v154
    v_mul_f32 v224, s13, v224
    v_mul_f32 v225, s13, v225
    v_cvt_pk_bf16_f32 v122, v224, v225
    v_lshlrev_b32 v226, 16, v155
    v_and_b32 v227, 0xffff0000, v155
    v_mul_f32 v226, s13, v226
    v_mul_f32 v227, s13, v227
    v_cvt_pk_bf16_f32 v123, v226, v227
    v_lshlrev_b32 v224, 16, v156
    v_and_b32 v225, 0xffff0000, v156
    v_mul_f32 v224, s13, v224
    v_mul_f32 v225, s13, v225
    v_cvt_pk_bf16_f32 v124, v224, v225
    v_lshlrev_b32 v226, 16, v157
    v_and_b32 v227, 0xffff0000, v157
    v_mul_f32 v226, s13, v226
    v_mul_f32 v227, s13, v227
    v_cvt_pk_bf16_f32 v125, v226, v227
    v_lshlrev_b32 v224, 16, v158
    v_and_b32 v225, 0xffff0000, v158
    v_mul_f32 v224, s13, v224
    v_mul_f32 v225, s13, v225
    v_cvt_pk_bf16_f32 v126, v224, v225
    v_lshlrev_b32 v226, 16, v159
    v_and_b32 v227, 0xffff0000, v159
    v_mul_f32 v226, s13, v226
    v_mul_f32 v227, s13, v227
    v_cvt_pk_bf16_f32 v127, v226, v227
    v_lshlrev_b32 v224, 16, v160
    v_and_b32 v225, 0xffff0000, v160
    v_mul_f32 v224, s13, v224
    v_mul_f32 v225, s13, v225
    v_cvt_pk_bf16_f32 v128, v224, v225
    v_lshlrev_b32 v226, 16, v161
    v_and_b32 v227, 0xffff0000, v161
    v_mul_f32 v226, s13, v226
    v_mul_f32 v227, s13, v227
    v_cvt_pk_bf16_f32 v129, v226, v227
    v_lshlrev_b32 v224, 16, v162
    v_and_b32 v225, 0xffff0000, v162
    v_mul_f32 v224, s13, v224
    v_mul_f32 v225, s13, v225
    v_cvt_pk_bf16_f32 v130, v224, v225
    v_lshlrev_b32 v226, 16, v163
    v_and_b32 v227, 0xffff0000, v163
    v_mul_f32 v226, s13, v226
    v_mul_f32 v227, s13, v227
    v_cvt_pk_bf16_f32 v131, v226, v227
    v_lshlrev_b32 v224, 16, v164
    v_and_b32 v225, 0xffff0000, v164
    v_mul_f32 v224, s13, v224
    v_mul_f32 v225, s13, v225
    v_cvt_pk_bf16_f32 v132, v224, v225
    v_lshlrev_b32 v226, 16, v165
    v_and_b32 v227, 0xffff0000, v165
    v_mul_f32 v226, s13, v226
    v_mul_f32 v227, s13, v227
    v_cvt_pk_bf16_f32 v133, v226, v227
    v_lshlrev_b32 v224, 16, v166
    v_and_b32 v225, 0xffff0000, v166
    v_mul_f32 v224, s13, v224
    v_mul_f32 v225, s13, v225
    v_cvt_pk_bf16_f32 v134, v224, v225
    v_lshlrev_b32 v226, 16, v167
    v_and_b32 v227, 0xffff0000, v167
    v_mul_f32 v226, s13, v226
    v_mul_f32 v227, s13, v227
    v_cvt_pk_bf16_f32 v135, v226, v227
    s_add_u32 s32, s14, 1
    s_lshl_b32 s32, s32, 3
    s_add_u32 s32, s32, s4
    s_lshl_b32 s32, s32, 2
    s_add_u32 s32, s32, s6
    s_lshl_b32 s32, s32, 13
    v_and_b32 v248, 15, v251
    v_lshrrev_b32 v249, 4, v251
    v_lshlrev_b32 v248, 8, v248
    v_lshl_add_u32 v248, v249, 4, v248
    v_add_u32 v249, 4096, v248
    s_cmp_lt_u32 s10, s8
    s_cselect_b32 s32, s32, 0x80000000
    buffer_load_dwordx4 v[136:139], v248, s[36:39], s32 offen offset:0
    buffer_load_dwordx4 v[140:143], v248, s[36:39], s32 offen offset:64
    buffer_load_dwordx4 v[144:147], v248, s[36:39], s32 offen offset:128
    buffer_load_dwordx4 v[148:151], v248, s[36:39], s32 offen offset:192
    buffer_load_dwordx4 v[152:155], v249, s[36:39], s32 offen offset:0
    buffer_load_dwordx4 v[156:159], v249, s[36:39], s32 offen offset:64
    buffer_load_dwordx4 v[160:163], v249, s[36:39], s32 offen offset:128
    buffer_load_dwordx4 v[164:167], v249, s[36:39], s32 offen offset:192
L_first:
    s_mov_b32 s32, s9
    s_mul_i32 s33, s9, 10923
    s_lshr_b32 s33, s33, 16
    s_mul_i32 s33, s33, 6
    s_sub_u32 s32, s9, s33
    s_lshl_b32 s33, s32, 13
    v_add_u32 v80, s33, v228
    v_add_u32 v81, s33, v229
    v_add_u32 v82, s33, v230
    v_add_u32 v83, s33, v231
    ds_read_b128 v[168:171], v80 offset:0
    ds_read_b128 v[172:175], v81 offset:0
    ds_read_b128 v[176:179], v82 offset:0
    ds_read_b128 v[180:183], v83 offset:0
    v_mov_b32 v0, 0
    v_mov_b32 v1, 0
    v_mov_b32 v2, 0
    v_mov_b32 v3, 0
    v_mov_b32 v4, 0
    v_mov_b32 v5, 0
    v_mov_b32 v6, 0
    v_mov_b32 v7, 0
    v_mov_b32 v8, 0
    v_mov_b32 v9, 0
    v_mov_b32 v10, 0
    v_mov_b32 v11, 0
    v_mov_b32 v12, 0
    v_mov_b32 v13, 0
    v_mov_b32 v14, 0
    v_mov_b32 v15, 0
    v_mov_b32 v16, 0
    v_mov_b32 v17, 0
    v_mov_b32 v18, 0
    v_mov_b32 v19, 0
    v_mov_b32 v20, 0
    v_mov_b32 v21, 0
    v_mov_b32 v22, 0
    v_mov_b32 v23, 0
    v_mov_b32 v24, 0
    v_mov_b32 v25, 0
    v_mov_b32 v26, 0
    v_mov_b32 v27, 0
    v_mov_b32 v28, 0
    v_mov_b32 v29, 0
    v_mov_b32 v30, 0
    v_mov_b32 v31, 0
    v_mov_b32 v32, 0
    v_mov_b32 v33, 0
    v_mov_b32 v34, 0
    v_mov_b32 v35, 0
    v_mov_b32 v36, 0
    v_mov_b32 v37, 0
    v_mov_b32 v38, 0
    v_mov_b32 v39, 0
    v_mov_b32 v40, 0
    v_mov_b32 v41, 0
    v_mov_b32 v42, 0
    v_mov_b32 v43, 0
    v_mov_b32 v44, 0
    v_mov_b32 v45, 0
    v_mov_b32 v46, 0
    v_mov_b32 v47, 0
    v_mov_b32 v48, 0
    v_mov_b32 v49, 0
    v_mov_b32 v50, 0
    v_mov_b32 v51, 0
    v_mov_b32 v52, 0
    v_mov_b32 v53, 0
    v_mov_b32 v54, 0
    v_mov_b32 v55, 0
    v_mov_b32 v56, 0
    v_mov_b32 v57, 0
    v_mov_b32 v58, 0
    v_mov_b32 v59, 0
    v_mov_b32 v60, 0
    v_mov_b32 v61, 0
    v_mov_b32 v62, 0
    v_mov_b32 v63, 0
    v_mov_b32 v240, 0
    v_mov_b32 v241, 0
    v_mov_b32 v242, 0
    v_mov_b32 v243, 0
    s_waitcnt lgkmcnt(3)
    v_mfma_f32_16x16x32_bf16 v[64:67], v[168:171], v[104:107], 0
    v_mfma_f32_16x16x32_bf16 v[68:71], v[168:171], v[120:123], 0
    ds_read_b128 v[168:171], v80 offset:4096
    s_waitcnt lgkmcnt(3)
    v_mfma_f32_16x16x32_bf16 v[64:67], v[172:175], v[108:111], v[64:67]
    v_mfma_f32_16x16x32_bf16 v[68:71], v[172:175], v[124:127], v[68:71]
    ds_read_b128 v[172:175], v81 offset:4096
    s_waitcnt lgkmcnt(3)
    v_mfma_f32_16x16x32_bf16 v[64:67], v[176:179], v[112:115], v[64:67]
    v_mfma_f32_16x16x32_bf16 v[68:71], v[176:179], v[128:131], v[68:71]
    ds_read_b128 v[176:179], v82 offset:4096
    s_waitcnt lgkmcnt(3)
    v_mfma_f32_16x16x32_bf16 v[64:67], v[180:183], v[116:119], v[64:67]
    v_mfma_f32_16x16x32_bf16 v[68:71], v[180:183], v[132:135], v[68:71]
    ds_read_b128 v[180:183], v83 offset:4096
    s_waitcnt lgkmcnt(3)
    v_mfma_f32_16x16x32_bf16 v[72:75], v[168:171], v[104:107], 0
    v_mfma_f32_16x16x32_bf16 v[76:79], v[168:171], v[120:123], 0
    s_waitcnt lgkmcnt(2)
    v_mfma_f32_16x16x32_bf16 v[72:75], v[172:175], v[108:111], v[72:75]
    v_mfma_f32_16x16x32_bf16 v[76:79], v[172:175], v[124:127], v[76:79]
    s_waitcnt lgkmcnt(1)
    v_mfma_f32_16x16x32_bf16 v[72:75], v[176:179], v[112:115], v[72:75]
    v_mfma_f32_16x16x32_bf16 v[76:79], v[176:179], v[128:131], v[76:79]
    s_waitcnt lgkmcnt(0)
    v_mfma_f32_16x16x32_bf16 v[72:75], v[180:183], v[116:119], v[72:75]
    v_mfma_f32_16x16x32_bf16 v[76:79], v[180:183], v[132:135], v[76:79]
    s_nop 7
    s_cmp_lg_u32 s9, s11
    s_cbranch_scc1 L_f_nomask
    s_nop 7
    v_lshrrev_b32 v250, 4, v251
    v_lshlrev_b32 v250, 2, v250
    v_mov_b32 v248, 0xff800000
    v_add_u32 v249, 0, v250
    v_cmp_gt_u32 vcc, s12, v249
    s_nop 1
    v_cndmask_b32 v64, v248, v64, vcc
    v_cndmask_b32 v68, v248, v68, vcc
    v_add_u32 v249, 1, v250
    v_cmp_gt_u32 vcc, s12, v249
    s_nop 1
    v_cndmask_b32 v65, v248, v65, vcc
    v_cndmask_b32 v69, v248, v69, vcc
    v_add_u32 v249, 2, v250
    v_cmp_gt_u32 vcc, s12, v249
    s_nop 1
    v_cndmask_b32 v66, v248, v66, vcc
    v_cndmask_b32 v70, v248, v70, vcc
    v_add_u32 v249, 3, v250
    v_cmp_gt_u32 vcc, s12, v249
    s_nop 1
    v_cndmask_b32 v67, v248, v67, vcc
    v_cndmask_b32 v71, v248, v71, vcc
    v_add_u32 v249, 16, v250
    v_cmp_gt_u32 vcc, s12, v249
    s_nop 1
    v_cndmask_b32 v72, v248, v72, vcc
    v_cndmask_b32 v76, v248, v76, vcc
    v_add_u32 v249, 17, v250
    v_cmp_gt_u32 vcc, s12, v249
    s_nop 1
    v_cndmask_b32 v73, v248, v73, vcc
    v_cndmask_b32 v77, v248, v77, vcc
    v_add_u32 v249, 18, v250
    v_cmp_gt_u32 vcc, s12, v249
    s_nop 1
    v_cndmask_b32 v74, v248, v74, vcc
    v_cndmask_b32 v78, v248, v78, vcc
    v_add_u32 v249, 19, v250
    v_cmp_gt_u32 vcc, s12, v249
    s_nop 1
    v_cndmask_b32 v75, v248, v75, vcc
    v_cndmask_b32 v79, v248, v79, vcc
L_f_nomask:
    v_max3_f32 v248, v64, v65, v66
    v_max3_f32 v248, v248, v67, v72
    v_max3_f32 v248, v248, v73, v74
    v_max_f32 v248, v248, v75
    v_max3_f32 v252, v68, v69, v70
    v_max3_f32 v252, v252, v71, v76
    v_max3_f32 v252, v252, v77, v78
    v_max_f32 v252, v252, v79
    v_mov_b32 v249, v248
    v_mov_b32 v253, v252
    s_nop 1
    v_permlane16_swap_b32 v248, v249
    v_permlane16_swap_b32 v252, v253
    s_nop 1
    v_max_f32 v248, v248, v249
    v_max_f32 v252, v252, v253
    v_mov_b32 v249, v248
    v_mov_b32 v253, v252
    s_nop 1
    v_permlane32_swap_b32 v248, v249
    v_permlane32_swap_b32 v252, v253
    s_nop 1
    v_max_f32 v248, v248, v249
    v_max_f32 v252, v252, v253
    v_sub_f32 v64, v64, v248
    v_sub_f32 v65, v65, v248
    v_sub_f32 v66, v66, v248
    v_sub_f32 v67, v67, v248
    v_sub_f32 v72, v72, v248
    v_sub_f32 v73, v73, v248
    v_sub_f32 v74, v74, v248
    v_sub_f32 v75, v75, v248
    v_sub_f32 v96, 0, v248
    v_sub_f32 v97, 0, v248
    v_sub_f32 v98, 0, v248
    v_sub_f32 v99, 0, v248
    v_sub_f32 v68, v68, v252
    v_sub_f32 v69, v69, v252
    v_sub_f32 v70, v70, v252
    v_sub_f32 v71, v71, v252
    v_sub_f32 v76, v76, v252
    v_sub_f32 v77, v77, v252
    v_sub_f32 v78, v78, v252
    v_sub_f32 v79, v79, v252
    v_sub_f32 v100, 0, v252
    v_sub_f32 v101, 0, v252
    v_sub_f32 v102, 0, v252
    v_sub_f32 v103, 0, v252
    v_exp_f32 v224, v64
    v_exp_f32 v225, v65
    v_exp_f32 v226, v66
    v_exp_f32 v227, v67
    v_cvt_pk_bf16_f32 v216, v224, v225
    v_pk_add_f32 v[244:245], v[224:225], v[226:227]
    v_cvt_pk_bf16_f32 v217, v226, v227
    v_exp_f32 v224, v72
    v_exp_f32 v225, v73
    v_exp_f32 v226, v74
    v_pk_add_f32 v[244:245], v[244:245], v[224:225]
    v_exp_f32 v227, v75
    v_cvt_pk_bf16_f32 v218, v224, v225
    v_pk_add_f32 v[244:245], v[244:245], v[226:227]
    v_cvt_pk_bf16_f32 v219, v226, v227
    s_bitcmp0_b32 s32, 0
    s_cbranch_scc1 L_f_even
    v_mov_b32 v88, v72
    v_mov_b32 v89, v73
    v_mov_b32 v90, v74
    v_mov_b32 v91, v75
    v_mov_b32 v92, v76
    v_mov_b32 v93, v77
    v_mov_b32 v94, v78
    v_mov_b32 v95, v79
    v_mov_b32 v80, v64
    v_mov_b32 v81, v65
    v_mov_b32 v82, v66
    v_mov_b32 v83, v67
    v_mov_b32 v84, v68
    v_mov_b32 v85, v69
    v_mov_b32 v86, v70
    v_mov_b32 v87, v71
L_f_even:
    s_add_u32 s9, s9, 1
    s_cmp_eq_u32 s32, 0
    s_cbranch_scc1 L_ph1
    s_cmp_eq_u32 s32, 1
    s_cbranch_scc1 L_ph2
    s_cmp_eq_u32 s32, 2
    s_cbranch_scc1 L_ph3
    s_cmp_eq_u32 s32, 3
    s_cbranch_scc1 L_ph4
    s_cmp_eq_u32 s32, 4
    s_cbranch_scc1 L_ph5
    s_branch L_ph0
L_pdone:
    s_waitcnt vmcnt(0)
    s_mov_b32 s96, 0x100000
L_gob:
    v_readfirstlane_b32 s3, v254
    s_cmp_lg_u32 s3, 0
    s_cbranch_scc1 L_gob_ok
    buffer_load_dword v254, off, s[40:43], s91 sc1
    s_sub_u32 s96, s96, 1
    s_waitcnt vmcnt(0)
    s_cbranch_scc0 L_gob
L_gob_ok:
    v_mov_b32 v250, 1
    s_mov_b64 exec, 1
    buffer_store_dword v250, off, s[48:51], s90 sc1
    s_mov_b64 exec, -1
    s_branch L_done
L_merge:
    s_bcnt1_i32_b64 s85, s[86:87]
    s_cmp_eq_u32 s85, 0
    s_cbranch_scc1 L_out
L_merge2:
    s_mov_b32 s96, 0x100000
L_goc:
    v_readfirstlane_b32 s3, v254
    s_cmp_lg_u32 s3, 0
    s_cbranch_scc1 L_goc_ok
    buffer_load_dword v254, off, s[40:43], s91 sc1
    s_sub_u32 s96, s96, 1
    s_waitcnt vmcnt(0)
    s_cbranch_scc0 L_goc
L_goc_ok:
    s_add_u32 s97, s97, s14
    s_lshl_b32 s90, s97, 2
    s_add_u32 s90, s90, s6
    s_lshl_b32 s90, s90, 6
    s_add_u32 s90, s90, 14680064
    v_lshlrev_b32 v236, 8, v251
    s_mov_b64 exec, s[86:87]
    buffer_load_dword v237, v236, s[48:51], s90 offen sc1
    s_mov_b64 exec, -1
L_pfd:
    v_sub_f32 v216, 0, v96
    v_sub_f32 v217, 0, v100
    v_and_b32 v250, 15, v251
    v_lshlrev_b32 v250, 3, v250
    v_add_u32 v250, 11534336, v250
    v_lshlrev_b32 v222, 4, v251
    v_add_u32 v223, 4096, v222
    s_mov_b64 exec, s[86:87]
L_poll:
    s_waitcnt vmcnt(0)
L_pollc:
    v_cmp_eq_u32 vcc, 1, v237
    s_sub_u32 s96, s96, 1
    s_cbranch_scc1 L_all
    s_cbranch_vccnz L_ready
    buffer_load_dword v237, v236, s[48:51], s90 offen sc1
    s_branch L_poll
L_all:
    s_mov_b32 s96, 0
    s_mov_b64 vcc, s[86:87]
L_ready:
    s_mov_b64 exec, -1
    s_bcnt1_i32_b64 s85, vcc
    s_cmp_gt_i32 s85, 2
    s_cbranch_scc1 L_rbig
    s_ff1_i32_b64 s32, vcc
    s_bitset0_b64 vcc, s32
    s_bitset0_b64 s[86:87], s32
    s_add_u32 s32, s32, s97
    s_lshl_b32 s32, s32, 2
    s_add_u32 s32, s32, s6
    s_lshl_b32 s33, s32, 9
    s_lshl_b32 s98, s32, 13
    buffer_load_dwordx2 v[168:169], v250, s[48:51], s33 offen sc1
    buffer_load_dwordx2 v[170:171], v250, s[48:51], s33 offen offset:128 sc1
    s_ff1_i32_b64 s32, vcc
    s_bitset0_b64 vcc, s32
    s_bitset0_b64 s[86:87], s32
    s_add_u32 s32, s32, s97
    s_lshl_b32 s32, s32, 2
    s_add_u32 s32, s32, s6
    s_lshl_b32 s33, s32, 9
    s_lshl_b32 s99, s32, 13
    s_cmp_gt_i32 s85, 1
    s_cselect_b32 s33, s33, 0x80000000
    s_cselect_b32 s99, s99, 0x80000000
    buffer_load_dwordx2 v[172:173], v250, s[48:51], s33 offen sc1
    buffer_load_dwordx2 v[174:175], v250, s[48:51], s33 offen offset:128 sc1
    buffer_load_dwordx4 v[64:67], v222, s[48:51], s98 offen offset:0 sc1
    buffer_load_dwordx4 v[68:71], v222, s[48:51], s98 offen offset:1024 sc1
    buffer_load_dwordx4 v[72:75], v222, s[48:51], s98 offen offset:2048 sc1
    buffer_load_dwordx4 v[76:79], v222, s[48:51], s98 offen offset:3072 sc1
    buffer_load_dwordx4 v[80:83], v223, s[48:51], s98 offen offset:0 sc1
    buffer_load_dwordx4 v[84:87], v223, s[48:51], s98 offen offset:1024 sc1
    buffer_load_dwordx4 v[88:91], v223, s[48:51], s98 offen offset:2048 sc1
    buffer_load_dwordx4 v[92:95], v223, s[48:51], s98 offen offset:3072 sc1
    buffer_load_dwordx4 v[104:107], v222, s[48:51], s99 offen offset:0 sc1
    buffer_load_dwordx4 v[108:111], v222, s[48:51], s99 offen offset:1024 sc1
    buffer_load_dwordx4 v[112:115], v222, s[48:51], s99 offen offset:2048 sc1
    buffer_load_dwordx4 v[116:119], v222, s[48:51], s99 offen offset:3072 sc1
    buffer_load_dwordx4 v[120:123], v223, s[48:51], s99 offen offset:0 sc1
    buffer_load_dwordx4 v[124:127], v223, s[48:51], s99 offen offset:1024 sc1
    buffer_load_dwordx4 v[128:131], v223, s[48:51], s99 offen offset:2048 sc1
    buffer_load_dwordx4 v[132:135], v223, s[48:51], s99 offen offset:3072 sc1
    s_waitcnt vmcnt(16)
    s_cmp_eq_u64 s[86:87], 0
    s_cselect_b32 s3, 0x80000000, s90
    s_cselect_b64 exec, -1, s[86:87]
    buffer_load_dword v237, v236, s[48:51], s3 offen sc1
    s_mov_b64 exec, -1
    s_cmp_gt_i32 s85, 1
    s_cselect_b32 s3, 0, 0xff800000
    v_add_f32 v172, s3, v172
    v_add_f32 v174, s3, v174
    v_max3_f32 v224, v216, v168, v172
    v_max3_f32 v225, v217, v170, v174
    v_sub_f32 v218, v216, v224
    v_mov_b32 v216, v224
    v_sub_f32 v168, v168, v224
    v_sub_f32 v172, v172, v224
    v_sub_f32 v220, v217, v225
    v_mov_b32 v217, v225
    v_sub_f32 v170, v170, v225
    v_sub_f32 v174, v174, v225
    v_exp_f32 v218, v218
    v_exp_f32 v168, v168
    v_exp_f32 v172, v172
    v_exp_f32 v220, v220
    v_exp_f32 v170, v170
    v_exp_f32 v174, v174
    s_nop 0
    v_mul_f32 v248, v248, v218
    v_fmac_f32 v248, v169, v168
    v_fmac_f32 v248, v173, v172
    v_mul_f32 v252, v252, v220
    v_fmac_f32 v252, v171, v170
    v_fmac_f32 v252, v175, v174
    v_pk_mul_f32 v[0:1], v[0:1], v[218:219] op_sel_hi:[1,0]
    v_pk_mul_f32 v[2:3], v[2:3], v[218:219] op_sel_hi:[1,0]
    v_pk_mul_f32 v[4:5], v[4:5], v[220:221] op_sel_hi:[1,0]
    v_pk_mul_f32 v[6:7], v[6:7], v[220:221] op_sel_hi:[1,0]
    v_pk_mul_f32 v[8:9], v[8:9], v[218:219] op_sel_hi:[1,0]
    v_pk_mul_f32 v[10:11], v[10:11], v[218:219] op_sel_hi:[1,0]
    v_pk_mul_f32 v[12:13], v[12:13], v[220:221] op_sel_hi:[1,0]
    v_pk_mul_f32 v[14:15], v[14:15], v[220:221] op_sel_hi:[1,0]
    v_pk_mul_f32 v[16:17], v[16:17], v[218:219] op_sel_hi:[1,0]
    v_pk_mul_f32 v[18:19], v[18:19], v[218:219] op_sel_hi:[1,0]
    v_pk_mul_f32 v[20:21], v[20:21], v[220:221] op_sel_hi:[1,0]
    v_pk_mul_f32 v[22:23], v[22:23], v[220:221] op_sel_hi:[1,0]
    v_pk_mul_f32 v[24:25], v[24:25], v[218:219] op_sel_hi:[1,0]
    v_pk_mul_f32 v[26:27], v[26:27], v[218:219] op_sel_hi:[1,0]
    v_pk_mul_f32 v[28:29], v[28:29], v[220:221] op_sel_hi:[1,0]
    v_pk_mul_f32 v[30:31], v[30:31], v[220:221] op_sel_hi:[1,0]
    v_pk_mul_f32 v[32:33], v[32:33], v[218:219] op_sel_hi:[1,0]
    v_pk_mul_f32 v[34:35], v[34:35], v[218:219] op_sel_hi:[1,0]
    v_pk_mul_f32 v[36:37], v[36:37], v[220:221] op_sel_hi:[1,0]
    v_pk_mul_f32 v[38:39], v[38:39], v[220:221] op_sel_hi:[1,0]
    v_pk_mul_f32 v[40:41], v[40:41], v[218:219] op_sel_hi:[1,0]
    v_pk_mul_f32 v[42:43], v[42:43], v[218:219] op_sel_hi:[1,0]
    v_pk_mul_f32 v[44:45], v[44:45], v[220:221] op_sel_hi:[1,0]
    v_pk_mul_f32 v[46:47], v[46:47], v[220:221] op_sel_hi:[1,0]
    v_pk_mul_f32 v[48:49], v[48:49], v[218:219] op_sel_hi:[1,0]
    v_pk_mul_f32 v[50:51], v[50:51], v[218:219] op_sel_hi:[1,0]
    v_pk_mul_f32 v[52:53], v[52:53], v[220:221] op_sel_hi:[1,0]
    v_pk_mul_f32 v[54:55], v[54:55], v[220:221] op_sel_hi:[1,0]
    v_pk_mul_f32 v[56:57], v[56:57], v[218:219] op_sel_hi:[1,0]
    v_pk_mul_f32 v[58:59], v[58:59], v[218:219] op_sel_hi:[1,0]
    v_pk_mul_f32 v[60:61], v[60:61], v[220:221] op_sel_hi:[1,0]
    v_pk_mul_f32 v[62:63], v[62:63], v[220:221] op_sel_hi:[1,0]
    s_waitcnt vmcnt(13)
    v_lshlrev_b32 v224, 16, v64
    v_and_b32 v225, 0xffff0000, v64
    v_pk_fma_f32 v[0:1], v[224:225], v[168:169], v[0:1] op_sel_hi:[1,0,1]
    v_lshlrev_b32 v226, 16, v65
    v_and_b32 v227, 0xffff0000, v65
    v_pk_fma_f32 v[2:3], v[226:227], v[168:169], v[2:3] op_sel_hi:[1,0,1]
    v_lshlrev_b32 v224, 16, v66
    v_and_b32 v225, 0xffff0000, v66
    v_pk_fma_f32 v[8:9], v[224:225], v[168:169], v[8:9] op_sel_hi:[1,0,1]
    v_lshlrev_b32 v226, 16, v67
    v_and_b32 v227, 0xffff0000, v67
    v_pk_fma_f32 v[10:11], v[226:227], v[168:169], v[10:11] op_sel_hi:[1,0,1]
    v_lshlrev_b32 v224, 16, v68
    v_and_b32 v225, 0xffff0000, v68
    v_pk_fma_f32 v[16:17], v[224:225], v[168:169], v[16:17] op_sel_hi:[1,0,1]
    v_lshlrev_b32 v226, 16, v69
    v_and_b32 v227, 0xffff0000, v69
    v_pk_fma_f32 v[18:19], v[226:227], v[168:169], v[18:19] op_sel_hi:[1,0,1]
    v_lshlrev_b32 v224, 16, v70
    v_and_b32 v225, 0xffff0000, v70
    v_pk_fma_f32 v[24:25], v[224:225], v[168:169], v[24:25] op_sel_hi:[1,0,1]
    v_lshlrev_b32 v226, 16, v71
    v_and_b32 v227, 0xffff0000, v71
    v_pk_fma_f32 v[26:27], v[226:227], v[168:169], v[26:27] op_sel_hi:[1,0,1]
    v_lshlrev_b32 v224, 16, v72
    v_and_b32 v225, 0xffff0000, v72
    v_pk_fma_f32 v[32:33], v[224:225], v[168:169], v[32:33] op_sel_hi:[1,0,1]
    v_lshlrev_b32 v226, 16, v73
    v_and_b32 v227, 0xffff0000, v73
    v_pk_fma_f32 v[34:35], v[226:227], v[168:169], v[34:35] op_sel_hi:[1,0,1]
    v_lshlrev_b32 v224, 16, v74
    v_and_b32 v225, 0xffff0000, v74
    v_pk_fma_f32 v[40:41], v[224:225], v[168:169], v[40:41] op_sel_hi:[1,0,1]
    v_lshlrev_b32 v226, 16, v75
    v_and_b32 v227, 0xffff0000, v75
    v_pk_fma_f32 v[42:43], v[226:227], v[168:169], v[42:43] op_sel_hi:[1,0,1]
    v_lshlrev_b32 v224, 16, v76
    v_and_b32 v225, 0xffff0000, v76
    v_pk_fma_f32 v[48:49], v[224:225], v[168:169], v[48:49] op_sel_hi:[1,0,1]
    v_lshlrev_b32 v226, 16, v77
    v_and_b32 v227, 0xffff0000, v77
    v_pk_fma_f32 v[50:51], v[226:227], v[168:169], v[50:51] op_sel_hi:[1,0,1]
    v_lshlrev_b32 v224, 16, v78
    v_and_b32 v225, 0xffff0000, v78
    v_pk_fma_f32 v[56:57], v[224:225], v[168:169], v[56:57] op_sel_hi:[1,0,1]
    v_lshlrev_b32 v226, 16, v79
    v_and_b32 v227, 0xffff0000, v79
    v_pk_fma_f32 v[58:59], v[226:227], v[168:169], v[58:59] op_sel_hi:[1,0,1]
    s_waitcnt vmcnt(9)
    v_lshlrev_b32 v224, 16, v80
    v_and_b32 v225, 0xffff0000, v80
    v_pk_fma_f32 v[4:5], v[224:225], v[170:171], v[4:5] op_sel_hi:[1,0,1]
    v_lshlrev_b32 v226, 16, v81
    v_and_b32 v227, 0xffff0000, v81
    v_pk_fma_f32 v[6:7], v[226:227], v[170:171], v[6:7] op_sel_hi:[1,0,1]
    v_lshlrev_b32 v224, 16, v82
    v_and_b32 v225, 0xffff0000, v82
    v_pk_fma_f32 v[12:13], v[224:225], v[170:171], v[12:13] op_sel_hi:[1,0,1]
    v_lshlrev_b32 v226, 16, v83
    v_and_b32 v227, 0xffff0000, v83
    v_pk_fma_f32 v[14:15], v[226:227], v[170:171], v[14:15] op_sel_hi:[1,0,1]
    v_lshlrev_b32 v224, 16, v84
    v_and_b32 v225, 0xffff0000, v84
    v_pk_fma_f32 v[20:21], v[224:225], v[170:171], v[20:21] op_sel_hi:[1,0,1]
    v_lshlrev_b32 v226, 16, v85
    v_and_b32 v227, 0xffff0000, v85
    v_pk_fma_f32 v[22:23], v[226:227], v[170:171], v[22:23] op_sel_hi:[1,0,1]
    v_lshlrev_b32 v224, 16, v86
    v_and_b32 v225, 0xffff0000, v86
    v_pk_fma_f32 v[28:29], v[224:225], v[170:171], v[28:29] op_sel_hi:[1,0,1]
    v_lshlrev_b32 v226, 16, v87
    v_and_b32 v227, 0xffff0000, v87
    v_pk_fma_f32 v[30:31], v[226:227], v[170:171], v[30:31] op_sel_hi:[1,0,1]
    v_lshlrev_b32 v224, 16, v88
    v_and_b32 v225, 0xffff0000, v88
    v_pk_fma_f32 v[36:37], v[224:225], v[170:171], v[36:37] op_sel_hi:[1,0,1]
    v_lshlrev_b32 v226, 16, v89
    v_and_b32 v227, 0xffff0000, v89
    v_pk_fma_f32 v[38:39], v[226:227], v[170:171], v[38:39] op_sel_hi:[1,0,1]
    v_lshlrev_b32 v224, 16, v90
    v_and_b32 v225, 0xffff0000, v90
    v_pk_fma_f32 v[44:45], v[224:225], v[170:171], v[44:45] op_sel_hi:[1,0,1]
    v_lshlrev_b32 v226, 16, v91
    v_and_b32 v227, 0xffff0000, v91
    v_pk_fma_f32 v[46:47], v[226:227], v[170:171], v[46:47] op_sel_hi:[1,0,1]
    v_lshlrev_b32 v224, 16, v92
    v_and_b32 v225, 0xffff0000, v92
    v_pk_fma_f32 v[52:53], v[224:225], v[170:171], v[52:53] op_sel_hi:[1,0,1]
    v_lshlrev_b32 v226, 16, v93
    v_and_b32 v227, 0xffff0000, v93
    v_pk_fma_f32 v[54:55], v[226:227], v[170:171], v[54:55] op_sel_hi:[1,0,1]
    v_lshlrev_b32 v224, 16, v94
    v_and_b32 v225, 0xffff0000, v94
    v_pk_fma_f32 v[60:61], v[224:225], v[170:171], v[60:61] op_sel_hi:[1,0,1]
    v_lshlrev_b32 v226, 16, v95
    v_and_b32 v227, 0xffff0000, v95
    v_pk_fma_f32 v[62:63], v[226:227], v[170:171], v[62:63] op_sel_hi:[1,0,1]
    s_cmp_gt_i32 s85, 1
    s_cbranch_scc0 L_rend
    s_waitcnt vmcnt(5)
    v_lshlrev_b32 v224, 16, v104
    v_and_b32 v225, 0xffff0000, v104
    v_pk_fma_f32 v[0:1], v[224:225], v[172:173], v[0:1] op_sel_hi:[1,0,1]
    v_lshlrev_b32 v226, 16, v105
    v_and_b32 v227, 0xffff0000, v105
    v_pk_fma_f32 v[2:3], v[226:227], v[172:173], v[2:3] op_sel_hi:[1,0,1]
    v_lshlrev_b32 v224, 16, v106
    v_and_b32 v225, 0xffff0000, v106
    v_pk_fma_f32 v[8:9], v[224:225], v[172:173], v[8:9] op_sel_hi:[1,0,1]
    v_lshlrev_b32 v226, 16, v107
    v_and_b32 v227, 0xffff0000, v107
    v_pk_fma_f32 v[10:11], v[226:227], v[172:173], v[10:11] op_sel_hi:[1,0,1]
    v_lshlrev_b32 v224, 16, v108
    v_and_b32 v225, 0xffff0000, v108
    v_pk_fma_f32 v[16:17], v[224:225], v[172:173], v[16:17] op_sel_hi:[1,0,1]
    v_lshlrev_b32 v226, 16, v109
    v_and_b32 v227, 0xffff0000, v109
    v_pk_fma_f32 v[18:19], v[226:227], v[172:173], v[18:19] op_sel_hi:[1,0,1]
    v_lshlrev_b32 v224, 16, v110
    v_and_b32 v225, 0xffff0000, v110
    v_pk_fma_f32 v[24:25], v[224:225], v[172:173], v[24:25] op_sel_hi:[1,0,1]
    v_lshlrev_b32 v226, 16, v111
    v_and_b32 v227, 0xffff0000, v111
    v_pk_fma_f32 v[26:27], v[226:227], v[172:173], v[26:27] op_sel_hi:[1,0,1]
    v_lshlrev_b32 v224, 16, v112
    v_and_b32 v225, 0xffff0000, v112
    v_pk_fma_f32 v[32:33], v[224:225], v[172:173], v[32:33] op_sel_hi:[1,0,1]
    v_lshlrev_b32 v226, 16, v113
    v_and_b32 v227, 0xffff0000, v113
    v_pk_fma_f32 v[34:35], v[226:227], v[172:173], v[34:35] op_sel_hi:[1,0,1]
    v_lshlrev_b32 v224, 16, v114
    v_and_b32 v225, 0xffff0000, v114
    v_pk_fma_f32 v[40:41], v[224:225], v[172:173], v[40:41] op_sel_hi:[1,0,1]
    v_lshlrev_b32 v226, 16, v115
    v_and_b32 v227, 0xffff0000, v115
    v_pk_fma_f32 v[42:43], v[226:227], v[172:173], v[42:43] op_sel_hi:[1,0,1]
    v_lshlrev_b32 v224, 16, v116
    v_and_b32 v225, 0xffff0000, v116
    v_pk_fma_f32 v[48:49], v[224:225], v[172:173], v[48:49] op_sel_hi:[1,0,1]
    v_lshlrev_b32 v226, 16, v117
    v_and_b32 v227, 0xffff0000, v117
    v_pk_fma_f32 v[50:51], v[226:227], v[172:173], v[50:51] op_sel_hi:[1,0,1]
    v_lshlrev_b32 v224, 16, v118
    v_and_b32 v225, 0xffff0000, v118
    v_pk_fma_f32 v[56:57], v[224:225], v[172:173], v[56:57] op_sel_hi:[1,0,1]
    v_lshlrev_b32 v226, 16, v119
    v_and_b32 v227, 0xffff0000, v119
    v_pk_fma_f32 v[58:59], v[226:227], v[172:173], v[58:59] op_sel_hi:[1,0,1]
    s_waitcnt vmcnt(1)
    v_lshlrev_b32 v224, 16, v120
    v_and_b32 v225, 0xffff0000, v120
    v_pk_fma_f32 v[4:5], v[224:225], v[174:175], v[4:5] op_sel_hi:[1,0,1]
    v_lshlrev_b32 v226, 16, v121
    v_and_b32 v227, 0xffff0000, v121
    v_pk_fma_f32 v[6:7], v[226:227], v[174:175], v[6:7] op_sel_hi:[1,0,1]
    v_lshlrev_b32 v224, 16, v122
    v_and_b32 v225, 0xffff0000, v122
    v_pk_fma_f32 v[12:13], v[224:225], v[174:175], v[12:13] op_sel_hi:[1,0,1]
    v_lshlrev_b32 v226, 16, v123
    v_and_b32 v227, 0xffff0000, v123
    v_pk_fma_f32 v[14:15], v[226:227], v[174:175], v[14:15] op_sel_hi:[1,0,1]
    v_lshlrev_b32 v224, 16, v124
    v_and_b32 v225, 0xffff0000, v124
    v_pk_fma_f32 v[20:21], v[224:225], v[174:175], v[20:21] op_sel_hi:[1,0,1]
    v_lshlrev_b32 v226, 16, v125
    v_and_b32 v227, 0xffff0000, v125
    v_pk_fma_f32 v[22:23], v[226:227], v[174:175], v[22:23] op_sel_hi:[1,0,1]
    v_lshlrev_b32 v224, 16, v126
    v_and_b32 v225, 0xffff0000, v126
    v_pk_fma_f32 v[28:29], v[224:225], v[174:175], v[28:29] op_sel_hi:[1,0,1]
    v_lshlrev_b32 v226, 16, v127
    v_and_b32 v227, 0xffff0000, v127
    v_pk_fma_f32 v[30:31], v[226:227], v[174:175], v[30:31] op_sel_hi:[1,0,1]
    v_lshlrev_b32 v224, 16, v128
    v_and_b32 v225, 0xffff0000, v128
    v_pk_fma_f32 v[36:37], v[224:225], v[174:175], v[36:37] op_sel_hi:[1,0,1]
    v_lshlrev_b32 v226, 16, v129
    v_and_b32 v227, 0xffff0000, v129
    v_pk_fma_f32 v[38:39], v[226:227], v[174:175], v[38:39] op_sel_hi:[1,0,1]
    v_lshlrev_b32 v224, 16, v130
    v_and_b32 v225, 0xffff0000, v130
    v_pk_fma_f32 v[44:45], v[224:225], v[174:175], v[44:45] op_sel_hi:[1,0,1]
    v_lshlrev_b32 v226, 16, v131
    v_and_b32 v227, 0xffff0000, v131
    v_pk_fma_f32 v[46:47], v[226:227], v[174:175], v[46:47] op_sel_hi:[1,0,1]
    v_lshlrev_b32 v224, 16, v132
    v_and_b32 v225, 0xffff0000, v132
    v_pk_fma_f32 v[52:53], v[224:225], v[174:175], v[52:53] op_sel_hi:[1,0,1]
    v_lshlrev_b32 v226, 16, v133
    v_and_b32 v227, 0xffff0000, v133
    v_pk_fma_f32 v[54:55], v[226:227], v[174:175], v[54:55] op_sel_hi:[1,0,1]
    v_lshlrev_b32 v224, 16, v134
    v_and_b32 v225, 0xffff0000, v134
    v_pk_fma_f32 v[60:61], v[224:225], v[174:175], v[60:61] op_sel_hi:[1,0,1]
    v_lshlrev_b32 v226, 16, v135
    v_and_b32 v227, 0xffff0000, v135
    v_pk_fma_f32 v[62:63], v[226:227], v[174:175], v[62:63] op_sel_hi:[1,0,1]
    s_branch L_rend
L_rbig:
    s_ff1_i32_b64 s32, vcc
    s_bitset0_b64 vcc, s32
    s_bitset0_b64 s[86:87], s32
    s_add_u32 s32, s32, s97
    s_lshl_b32 s32, s32, 2
    s_add_u32 s32, s32, s6
    s_lshl_b32 s33, s32, 9
    s_lshl_b32 s98, s32, 13
    buffer_load_dwordx2 v[168:169], v250, s[48:51], s33 offen sc1
    buffer_load_dwordx2 v[170:171], v250, s[48:51], s33 offen offset:128 sc1
    s_ff1_i32_b64 s32, vcc
    s_bitset0_b64 vcc, s32
    s_bitset0_b64 s[86:87], s32
    s_add_u32 s32, s32, s97
    s_lshl_b32 s32, s32, 2
    s_add_u32 s32, s32, s6
    s_lshl_b32 s33, s32, 9
    s_lshl_b32 s99, s32, 13
    buffer_load_dwordx2 v[172:173], v250, s[48:51], s33 offen sc1
    buffer_load_dwordx2 v[174:175], v250, s[48:51], s33 offen offset:128 sc1
    s_ff1_i32_b64 s32, vcc
    s_bitset0_b64 vcc, s32
    s_bitset0_b64 s[86:87], s32
    s_add_u32 s32, s32, s97
    s_lshl_b32 s32, s32, 2
    s_add_u32 s32, s32, s6
    s_lshl_b32 s33, s32, 9
    s_lshl_b32 s100, s32, 13
    buffer_load_dwordx2 v[176:177], v250, s[48:51], s33 offen sc1
    buffer_load_dwordx2 v[178:179], v250, s[48:51], s33 offen offset:128 sc1
    s_ff1_i32_b64 s32, vcc
    s_bitset0_b64 vcc, s32
    s_bitset0_b64 s[86:87], s32
    s_add_u32 s32, s32, s97
    s_lshl_b32 s32, s32, 2
    s_add_u32 s32, s32, s6
    s_lshl_b32 s33, s32, 9
    s_lshl_b32 s101, s32, 13
    s_cmp_gt_i32 s85, 3
    s_cselect_b32 s33, s33, 0x80000000
    s_cselect_b32 s101, s101, 0x80000000
    buffer_load_dwordx2 v[180:181], v250, s[48:51], s33 offen sc1
    buffer_load_dwordx2 v[182:183], v250, s[48:51], s33 offen offset:128 sc1
    s_ff1_i32_b64 s32, vcc
    s_bitset0_b64 vcc, s32
    s_bitset0_b64 s[86:87], s32
    s_add_u32 s32, s32, s97
    s_lshl_b32 s32, s32, 2
    s_add_u32 s32, s32, s6
    s_lshl_b32 s33, s32, 9
    s_lshl_b32 s94, s32, 13
    s_cmp_gt_i32 s85, 4
    s_cselect_b32 s33, s33, 0x80000000
    s_cselect_b32 s94, s94, 0x80000000
    buffer_load_dwordx2 v[228:229], v250, s[48:51], s33 offen sc1
    buffer_load_dwordx2 v[230:231], v250, s[48:51], s33 offen offset:128 sc1
    s_ff1_i32_b64 s32, vcc
    s_bitset0_b64 vcc, s32
    s_bitset0_b64 s[86:87], s32
    s_add_u32 s32, s32, s97
    s_lshl_b32 s32, s32, 2
    s_add_u32 s32, s32, s6
    s_lshl_b32 s33, s32, 9
    s_lshl_b32 s95, s32, 13
    s_cmp_gt_i32 s85, 5
    s_cselect_b32 s33, s33, 0x80000000
    s_cselect_b32 s95, s95, 0x80000000
    buffer_load_dwordx2 v[232:233], v250, s[48:51], s33 offen sc1
    buffer_load_dwordx2 v[234:235], v250, s[48:51], s33 offen offset:128 sc1
    buffer_load_dwordx4 v[64:67], v222, s[48:51], s98 offen offset:0 sc1
    buffer_load_dwordx4 v[68:71], v222, s[48:51], s98 offen offset:1024 sc1
    buffer_load_dwordx4 v[72:75], v222, s[48:51], s98 offen offset:2048 sc1
    buffer_load_dwordx4 v[76:79], v222, s[48:51], s98 offen offset:3072 sc1
    buffer_load_dwordx4 v[80:83], v223, s[48:51], s98 offen offset:0 sc1
    buffer_load_dwordx4 v[84:87], v223, s[48:51], s98 offen offset:1024 sc1
    buffer_load_dwordx4 v[88:91], v223, s[48:51], s98 offen offset:2048 sc1
    buffer_load_dwordx4 v[92:95], v223, s[48:51], s98 offen offset:3072 sc1
    buffer_load_dwordx4 v[104:107], v222, s[48:51], s99 offen offset:0 sc1
    buffer_load_dwordx4 v[108:111], v222, s[48:51], s99 offen offset:1024 sc1
    buffer_load_dwordx4 v[112:115], v222, s[48:51], s99 offen offset:2048 sc1
    buffer_load_dwordx4 v[116:119], v222, s[48:51], s99 offen offset:3072 sc1
    buffer_load_dwordx4 v[120:123], v223, s[48:51], s99 offen offset:0 sc1
    buffer_load_dwordx4 v[124:127], v223, s[48:51], s99 offen offset:1024 sc1
    buffer_load_dwordx4 v[128:131], v223, s[48:51], s99 offen offset:2048 sc1
    buffer_load_dwordx4 v[132:135], v223, s[48:51], s99 offen offset:3072 sc1
    buffer_load_dwordx4 v[136:139], v222, s[48:51], s100 offen offset:0 sc1
    buffer_load_dwordx4 v[140:143], v222, s[48:51], s100 offen offset:1024 sc1
    buffer_load_dwordx4 v[144:147], v222, s[48:51], s100 offen offset:2048 sc1
    buffer_load_dwordx4 v[148:151], v222, s[48:51], s100 offen offset:3072 sc1
    buffer_load_dwordx4 v[152:155], v223, s[48:51], s100 offen offset:0 sc1
    buffer_load_dwordx4 v[156:159], v223, s[48:51], s100 offen offset:1024 sc1
    buffer_load_dwordx4 v[160:163], v223, s[48:51], s100 offen offset:2048 sc1
    buffer_load_dwordx4 v[164:167], v223, s[48:51], s100 offen offset:3072 sc1
    buffer_load_dwordx4 v[184:187], v222, s[48:51], s101 offen offset:0 sc1
    buffer_load_dwordx4 v[188:191], v222, s[48:51], s101 offen offset:1024 sc1
    buffer_load_dwordx4 v[192:195], v222, s[48:51], s101 offen offset:2048 sc1
    buffer_load_dwordx4 v[196:199], v222, s[48:51], s101 offen offset:3072 sc1
    buffer_load_dwordx4 v[200:203], v223, s[48:51], s101 offen offset:0 sc1
    buffer_load_dwordx4 v[204:207], v223, s[48:51], s101 offen offset:1024 sc1
    buffer_load_dwordx4 v[208:211], v223, s[48:51], s101 offen offset:2048 sc1
    buffer_load_dwordx4 v[212:215], v223, s[48:51], s101 offen offset:3072 sc1
    s_waitcnt vmcnt(32)
    s_cmp_eq_u64 s[86:87], 0
    s_cselect_b32 s3, 0x80000000, s90
    s_cselect_b64 exec, -1, s[86:87]
    buffer_load_dword v237, v236, s[48:51], s3 offen sc1
    s_mov_b64 exec, -1
    s_cmp_gt_i32 s85, 3
    s_cselect_b32 s3, 0, 0xff800000
    v_add_f32 v180, s3, v180
    v_add_f32 v182, s3, v182
    s_cmp_gt_i32 s85, 4
    s_cselect_b32 s3, 0, 0xff800000
    v_add_f32 v228, s3, v228
    v_add_f32 v230, s3, v230
    s_cmp_gt_i32 s85, 5
    s_cselect_b32 s3, 0, 0xff800000
    v_add_f32 v232, s3, v232
    v_add_f32 v234, s3, v234
    v_max3_f32 v224, v216, v168, v172
    v_max3_f32 v225, v217, v170, v174
    v_max3_f32 v224, v224, v176, v180
    v_max3_f32 v225, v225, v178, v182
    v_max3_f32 v224, v224, v228, v232
    v_max3_f32 v225, v225, v230, v234
    v_sub_f32 v218, v216, v224
    v_mov_b32 v216, v224
    v_sub_f32 v168, v168, v224
    v_sub_f32 v172, v172, v224
    v_sub_f32 v176, v176, v224
    v_sub_f32 v180, v180, v224
    v_sub_f32 v228, v228, v224
    v_sub_f32 v232, v232, v224
    v_sub_f32 v220, v217, v225
    v_mov_b32 v217, v225
    v_sub_f32 v170, v170, v225
    v_sub_f32 v174, v174, v225
    v_sub_f32 v178, v178, v225
    v_sub_f32 v182, v182, v225
    v_sub_f32 v230, v230, v225
    v_sub_f32 v234, v234, v225
    v_exp_f32 v218, v218
    v_exp_f32 v168, v168
    v_exp_f32 v172, v172
    v_exp_f32 v176, v176
    v_exp_f32 v180, v180
    v_exp_f32 v228, v228
    v_exp_f32 v232, v232
    v_exp_f32 v220, v220
    v_exp_f32 v170, v170
    v_exp_f32 v174, v174
    v_exp_f32 v178, v178
    v_exp_f32 v182, v182
    v_exp_f32 v230, v230
    v_exp_f32 v234, v234
    s_nop 0
    v_mul_f32 v248, v248, v218
    v_fmac_f32 v248, v169, v168
    v_fmac_f32 v248, v173, v172
    v_fmac_f32 v248, v177, v176
    v_fmac_f32 v248, v181, v180
    v_fmac_f32 v248, v229, v228
    v_fmac_f32 v248, v233, v232
    v_mul_f32 v252, v252, v220
    v_fmac_f32 v252, v171, v170
    v_fmac_f32 v252, v175, v174
    v_fmac_f32 v252, v179, v178
    v_fmac_f32 v252, v183, v182
    v_fmac_f32 v252, v231, v230
    v_fmac_f32 v252, v235, v234
    v_pk_mul_f32 v[0:1], v[0:1], v[218:219] op_sel_hi:[1,0]
    v_pk_mul_f32 v[2:3], v[2:3], v[218:219] op_sel_hi:[1,0]
    v_pk_mul_f32 v[4:5], v[4:5], v[220:221] op_sel_hi:[1,0]
    v_pk_mul_f32 v[6:7], v[6:7], v[220:221] op_sel_hi:[1,0]
    v_pk_mul_f32 v[8:9], v[8:9], v[218:219] op_sel_hi:[1,0]
    v_pk_mul_f32 v[10:11], v[10:11], v[218:219] op_sel_hi:[1,0]
    v_pk_mul_f32 v[12:13], v[12:13], v[220:221] op_sel_hi:[1,0]
    v_pk_mul_f32 v[14:15], v[14:15], v[220:221] op_sel_hi:[1,0]
    v_pk_mul_f32 v[16:17], v[16:17], v[218:219] op_sel_hi:[1,0]
    v_pk_mul_f32 v[18:19], v[18:19], v[218:219] op_sel_hi:[1,0]
    v_pk_mul_f32 v[20:21], v[20:21], v[220:221] op_sel_hi:[1,0]
    v_pk_mul_f32 v[22:23], v[22:23], v[220:221] op_sel_hi:[1,0]
    v_pk_mul_f32 v[24:25], v[24:25], v[218:219] op_sel_hi:[1,0]
    v_pk_mul_f32 v[26:27], v[26:27], v[218:219] op_sel_hi:[1,0]
    v_pk_mul_f32 v[28:29], v[28:29], v[220:221] op_sel_hi:[1,0]
    v_pk_mul_f32 v[30:31], v[30:31], v[220:221] op_sel_hi:[1,0]
    v_pk_mul_f32 v[32:33], v[32:33], v[218:219] op_sel_hi:[1,0]
    v_pk_mul_f32 v[34:35], v[34:35], v[218:219] op_sel_hi:[1,0]
    v_pk_mul_f32 v[36:37], v[36:37], v[220:221] op_sel_hi:[1,0]
    v_pk_mul_f32 v[38:39], v[38:39], v[220:221] op_sel_hi:[1,0]
    v_pk_mul_f32 v[40:41], v[40:41], v[218:219] op_sel_hi:[1,0]
    v_pk_mul_f32 v[42:43], v[42:43], v[218:219] op_sel_hi:[1,0]
    v_pk_mul_f32 v[44:45], v[44:45], v[220:221] op_sel_hi:[1,0]
    v_pk_mul_f32 v[46:47], v[46:47], v[220:221] op_sel_hi:[1,0]
    v_pk_mul_f32 v[48:49], v[48:49], v[218:219] op_sel_hi:[1,0]
    v_pk_mul_f32 v[50:51], v[50:51], v[218:219] op_sel_hi:[1,0]
    v_pk_mul_f32 v[52:53], v[52:53], v[220:221] op_sel_hi:[1,0]
    v_pk_mul_f32 v[54:55], v[54:55], v[220:221] op_sel_hi:[1,0]
    v_pk_mul_f32 v[56:57], v[56:57], v[218:219] op_sel_hi:[1,0]
    v_pk_mul_f32 v[58:59], v[58:59], v[218:219] op_sel_hi:[1,0]
    v_pk_mul_f32 v[60:61], v[60:61], v[220:221] op_sel_hi:[1,0]
    v_pk_mul_f32 v[62:63], v[62:63], v[220:221] op_sel_hi:[1,0]
    s_waitcnt vmcnt(29)
    v_lshlrev_b32 v224, 16, v64
    v_and_b32 v225, 0xffff0000, v64
    v_pk_fma_f32 v[0:1], v[224:225], v[168:169], v[0:1] op_sel_hi:[1,0,1]
    v_lshlrev_b32 v226, 16, v65
    v_and_b32 v227, 0xffff0000, v65
    v_pk_fma_f32 v[2:3], v[226:227], v[168:169], v[2:3] op_sel_hi:[1,0,1]
    v_lshlrev_b32 v224, 16, v66
    v_and_b32 v225, 0xffff0000, v66
    v_pk_fma_f32 v[8:9], v[224:225], v[168:169], v[8:9] op_sel_hi:[1,0,1]
    v_lshlrev_b32 v226, 16, v67
    v_and_b32 v227, 0xffff0000, v67
    v_pk_fma_f32 v[10:11], v[226:227], v[168:169], v[10:11] op_sel_hi:[1,0,1]
    v_lshlrev_b32 v224, 16, v68
    v_and_b32 v225, 0xffff0000, v68
    v_pk_fma_f32 v[16:17], v[224:225], v[168:169], v[16:17] op_sel_hi:[1,0,1]
    v_lshlrev_b32 v226, 16, v69
    v_and_b32 v227, 0xffff0000, v69
    v_pk_fma_f32 v[18:19], v[226:227], v[168:169], v[18:19] op_sel_hi:[1,0,1]
    v_lshlrev_b32 v224, 16, v70
    v_and_b32 v225, 0xffff0000, v70
    v_pk_fma_f32 v[24:25], v[224:225], v[168:169], v[24:25] op_sel_hi:[1,0,1]
    v_lshlrev_b32 v226, 16, v71
    v_and_b32 v227, 0xffff0000, v71
    v_pk_fma_f32 v[26:27], v[226:227], v[168:169], v[26:27] op_sel_hi:[1,0,1]
    v_lshlrev_b32 v224, 16, v72
    v_and_b32 v225, 0xffff0000, v72
    v_pk_fma_f32 v[32:33], v[224:225], v[168:169], v[32:33] op_sel_hi:[1,0,1]
    v_lshlrev_b32 v226, 16, v73
    v_and_b32 v227, 0xffff0000, v73
    v_pk_fma_f32 v[34:35], v[226:227], v[168:169], v[34:35] op_sel_hi:[1,0,1]
    v_lshlrev_b32 v224, 16, v74
    v_and_b32 v225, 0xffff0000, v74
    v_pk_fma_f32 v[40:41], v[224:225], v[168:169], v[40:41] op_sel_hi:[1,0,1]
    v_lshlrev_b32 v226, 16, v75
    v_and_b32 v227, 0xffff0000, v75
    v_pk_fma_f32 v[42:43], v[226:227], v[168:169], v[42:43] op_sel_hi:[1,0,1]
    v_lshlrev_b32 v224, 16, v76
    v_and_b32 v225, 0xffff0000, v76
    v_pk_fma_f32 v[48:49], v[224:225], v[168:169], v[48:49] op_sel_hi:[1,0,1]
    v_lshlrev_b32 v226, 16, v77
    v_and_b32 v227, 0xffff0000, v77
    v_pk_fma_f32 v[50:51], v[226:227], v[168:169], v[50:51] op_sel_hi:[1,0,1]
    v_lshlrev_b32 v224, 16, v78
    v_and_b32 v225, 0xffff0000, v78
    v_pk_fma_f32 v[56:57], v[224:225], v[168:169], v[56:57] op_sel_hi:[1,0,1]
    v_lshlrev_b32 v226, 16, v79
    v_and_b32 v227, 0xffff0000, v79
    v_pk_fma_f32 v[58:59], v[226:227], v[168:169], v[58:59] op_sel_hi:[1,0,1]
    buffer_load_dwordx4 v[64:67], v222, s[48:51], s94 offen offset:0 sc1
    buffer_load_dwordx4 v[68:71], v222, s[48:51], s94 offen offset:1024 sc1
    buffer_load_dwordx4 v[72:75], v222, s[48:51], s94 offen offset:2048 sc1
    buffer_load_dwordx4 v[76:79], v222, s[48:51], s94 offen offset:3072 sc1
    s_waitcnt vmcnt(29)
    v_lshlrev_b32 v224, 16, v80
    v_and_b32 v225, 0xffff0000, v80
    v_pk_fma_f32 v[4:5], v[224:225], v[170:171], v[4:5] op_sel_hi:[1,0,1]
    v_lshlrev_b32 v226, 16, v81
    v_and_b32 v227, 0xffff0000, v81
    v_pk_fma_f32 v[6:7], v[226:227], v[170:171], v[6:7] op_sel_hi:[1,0,1]
    v_lshlrev_b32 v224, 16, v82
    v_and_b32 v225, 0xffff0000, v82
    v_pk_fma_f32 v[12:13], v[224:225], v[170:171], v[12:13] op_sel_hi:[1,0,1]
    v_lshlrev_b32 v226, 16, v83
    v_and_b32 v227, 0xffff0000, v83
    v_pk_fma_f32 v[14:15], v[226:227], v[170:171], v[14:15] op_sel_hi:[1,0,1]
    v_lshlrev_b32 v224, 16, v84
    v_and_b32 v225, 0xffff0000, v84
    v_pk_fma_f32 v[20:21], v[224:225], v[170:171], v[20:21] op_sel_hi:[1,0,1]
    v_lshlrev_b32 v226, 16, v85
    v_and_b32 v227, 0xffff0000, v85
    v_pk_fma_f32 v[22:23], v[226:227], v[170:171], v[22:23] op_sel_hi:[1,0,1]
    v_lshlrev_b32 v224, 16, v86
    v_and_b32 v225, 0xffff0000, v86
    v_pk_fma_f32 v[28:29], v[224:225], v[170:171], v[28:29] op_sel_hi:[1,0,1]
    v_lshlrev_b32 v226, 16, v87
    v_and_b32 v227, 0xffff0000, v87
    v_pk_fma_f32 v[30:31], v[226:227], v[170:171], v[30:31] op_sel_hi:[1,0,1]
    v_lshlrev_b32 v224, 16, v88
    v_and_b32 v225, 0xffff0000, v88
    v_pk_fma_f32 v[36:37], v[224:225], v[170:171], v[36:37] op_sel_hi:[1,0,1]
    v_lshlrev_b32 v226, 16, v89
    v_and_b32 v227, 0xffff0000, v89
    v_pk_fma_f32 v[38:39], v[226:227], v[170:171], v[38:39] op_sel_hi:[1,0,1]
    v_lshlrev_b32 v224, 16, v90
    v_and_b32 v225, 0xffff0000, v90
    v_pk_fma_f32 v[44:45], v[224:225], v[170:171], v[44:45] op_sel_hi:[1,0,1]
    v_lshlrev_b32 v226, 16, v91
    v_and_b32 v227, 0xffff0000, v91
    v_pk_fma_f32 v[46:47], v[226:227], v[170:171], v[46:47] op_sel_hi:[1,0,1]
    v_lshlrev_b32 v224, 16, v92
    v_and_b32 v225, 0xffff0000, v92
    v_pk_fma_f32 v[52:53], v[224:225], v[170:171], v[52:53] op_sel_hi:[1,0,1]
    v_lshlrev_b32 v226, 16, v93
    v_and_b32 v227, 0xffff0000, v93
    v_pk_fma_f32 v[54:55], v[226:227], v[170:171], v[54:55] op_sel_hi:[1,0,1]
    v_lshlrev_b32 v224, 16, v94
    v_and_b32 v225, 0xffff0000, v94
    v_pk_fma_f32 v[60:61], v[224:225], v[170:171], v[60:61] op_sel_hi:[1,0,1]
    v_lshlrev_b32 v226, 16, v95
    v_and_b32 v227, 0xffff0000, v95
    v_pk_fma_f32 v[62:63], v[226:227], v[170:171], v[62:63] op_sel_hi:[1,0,1]
    buffer_load_dwordx4 v[80:83], v223, s[48:51], s94 offen offset:0 sc1
    buffer_load_dwordx4 v[84:87], v223, s[48:51], s94 offen offset:1024 sc1
    buffer_load_dwordx4 v[88:91], v223, s[48:51], s94 offen offset:2048 sc1
    buffer_load_dwordx4 v[92:95], v223, s[48:51], s94 offen offset:3072 sc1
    s_waitcnt vmcnt(29)
    v_lshlrev_b32 v224, 16, v104
    v_and_b32 v225, 0xffff0000, v104
    v_pk_fma_f32 v[0:1], v[224:225], v[172:173], v[0:1] op_sel_hi:[1,0,1]
    v_lshlrev_b32 v226, 16, v105
    v_and_b32 v227, 0xffff0000, v105
    v_pk_fma_f32 v[2:3], v[226:227], v[172:173], v[2:3] op_sel_hi:[1,0,1]
    v_lshlrev_b32 v224, 16, v106
    v_and_b32 v225, 0xffff0000, v106
    v_pk_fma_f32 v[8:9], v[224:225], v[172:173], v[8:9] op_sel_hi:[1,0,1]
    v_lshlrev_b32 v226, 16, v107
    v_and_b32 v227, 0xffff0000, v107
    v_pk_fma_f32 v[10:11], v[226:227], v[172:173], v[10:11] op_sel_hi:[1,0,1]
    v_lshlrev_b32 v224, 16, v108
    v_and_b32 v225, 0xffff0000, v108
    v_pk_fma_f32 v[16:17], v[224:225], v[172:173], v[16:17] op_sel_hi:[1,0,1]
    v_lshlrev_b32 v226, 16, v109
    v_and_b32 v227, 0xffff0000, v109
    v_pk_fma_f32 v[18:19], v[226:227], v[172:173], v[18:19] op_sel_hi:[1,0,1]
    v_lshlrev_b32 v224, 16, v110
    v_and_b32 v225, 0xffff0000, v110
    v_pk_fma_f32 v[24:25], v[224:225], v[172:173], v[24:25] op_sel_hi:[1,0,1]
    v_lshlrev_b32 v226, 16, v111
    v_and_b32 v227, 0xffff0000, v111
    v_pk_fma_f32 v[26:27], v[226:227], v[172:173], v[26:27] op_sel_hi:[1,0,1]
    v_lshlrev_b32 v224, 16, v112
    v_and_b32 v225, 0xffff0000, v112
    v_pk_fma_f32 v[32:33], v[224:225], v[172:173], v[32:33] op_sel_hi:[1,0,1]
    v_lshlrev_b32 v226, 16, v113
    v_and_b32 v227, 0xffff0000, v113
    v_pk_fma_f32 v[34:35], v[226:227], v[172:173], v[34:35] op_sel_hi:[1,0,1]
    v_lshlrev_b32 v224, 16, v114
    v_and_b32 v225, 0xffff0000, v114
    v_pk_fma_f32 v[40:41], v[224:225], v[172:173], v[40:41] op_sel_hi:[1,0,1]
    v_lshlrev_b32 v226, 16, v115
    v_and_b32 v227, 0xffff0000, v115
    v_pk_fma_f32 v[42:43], v[226:227], v[172:173], v[42:43] op_sel_hi:[1,0,1]
    v_lshlrev_b32 v224, 16, v116
    v_and_b32 v225, 0xffff0000, v116
    v_pk_fma_f32 v[48:49], v[224:225], v[172:173], v[48:49] op_sel_hi:[1,0,1]
    v_lshlrev_b32 v226, 16, v117
    v_and_b32 v227, 0xffff0000, v117
    v_pk_fma_f32 v[50:51], v[226:227], v[172:173], v[50:51] op_sel_hi:[1,0,1]
    v_lshlrev_b32 v224, 16, v118
    v_and_b32 v225, 0xffff0000, v118
    v_pk_fma_f32 v[56:57], v[224:225], v[172:173], v[56:57] op_sel_hi:[1,0,1]
    v_lshlrev_b32 v226, 16, v119
    v_and_b32 v227, 0xffff0000, v119
    v_pk_fma_f32 v[58:59], v[226:227], v[172:173], v[58:59] op_sel_hi:[1,0,1]
    buffer_load_dwordx4 v[104:107], v222, s[48:51], s95 offen offset:0 sc1
    buffer_load_dwordx4 v[108:111], v222, s[48:51], s95 offen offset:1024 sc1
    buffer_load_dwordx4 v[112:115], v222, s[48:51], s95 offen offset:2048 sc1
    buffer_load_dwordx4 v[116:119], v222, s[48:51], s95 offen offset:3072 sc1
    s_waitcnt vmcnt(29)
    v_lshlrev_b32 v224, 16, v120
    v_and_b32 v225, 0xffff0000, v120
    v_pk_fma_f32 v[4:5], v[224:225], v[174:175], v[4:5] op_sel_hi:[1,0,1]
    v_lshlrev_b32 v226, 16, v121
    v_and_b32 v227, 0xffff0000, v121
    v_pk_fma_f32 v[6:7], v[226:227], v[174:175], v[6:7] op_sel_hi:[1,0,1]
    v_lshlrev_b32 v224, 16, v122
    v_and_b32 v225, 0xffff0000, v122
    v_pk_fma_f32 v[12:13], v[224:225], v[174:175], v[12:13] op_sel_hi:[1,0,1]
    v_lshlrev_b32 v226, 16, v123
    v_and_b32 v227, 0xffff0000, v123
    v_pk_fma_f32 v[14:15], v[226:227], v[174:175], v[14:15] op_sel_hi:[1,0,1]
    v_lshlrev_b32 v224, 16, v124
    v_and_b32 v225, 0xffff0000, v124
    v_pk_fma_f32 v[20:21], v[224:225], v[174:175], v[20:21] op_sel_hi:[1,0,1]
    v_lshlrev_b32 v226, 16, v125
    v_and_b32 v227, 0xffff0000, v125
    v_pk_fma_f32 v[22:23], v[226:227], v[174:175], v[22:23] op_sel_hi:[1,0,1]
    v_lshlrev_b32 v224, 16, v126
    v_and_b32 v225, 0xffff0000, v126
    v_pk_fma_f32 v[28:29], v[224:225], v[174:175], v[28:29] op_sel_hi:[1,0,1]
    v_lshlrev_b32 v226, 16, v127
    v_and_b32 v227, 0xffff0000, v127
    v_pk_fma_f32 v[30:31], v[226:227], v[174:175], v[30:31] op_sel_hi:[1,0,1]
    v_lshlrev_b32 v224, 16, v128
    v_and_b32 v225, 0xffff0000, v128
    v_pk_fma_f32 v[36:37], v[224:225], v[174:175], v[36:37] op_sel_hi:[1,0,1]
    v_lshlrev_b32 v226, 16, v129
    v_and_b32 v227, 0xffff0000, v129
    v_pk_fma_f32 v[38:39], v[226:227], v[174:175], v[38:39] op_sel_hi:[1,0,1]
    v_lshlrev_b32 v224, 16, v130
    v_and_b32 v225, 0xffff0000, v130
    v_pk_fma_f32 v[44:45], v[224:225], v[174:175], v[44:45] op_sel_hi:[1,0,1]
    v_lshlrev_b32 v226, 16, v131
    v_and_b32 v227, 0xffff0000, v131
    v_pk_fma_f32 v[46:47], v[226:227], v[174:175], v[46:47] op_sel_hi:[1,0,1]
    v_lshlrev_b32 v224, 16, v132
    v_and_b32 v225, 0xffff0000, v132
    v_pk_fma_f32 v[52:53], v[224:225], v[174:175], v[52:53] op_sel_hi:[1,0,1]
    v_lshlrev_b32 v226, 16, v133
    v_and_b32 v227, 0xffff0000, v133
    v_pk_fma_f32 v[54:55], v[226:227], v[174:175], v[54:55] op_sel_hi:[1,0,1]
    v_lshlrev_b32 v224, 16, v134
    v_and_b32 v225, 0xffff0000, v134
    v_pk_fma_f32 v[60:61], v[224:225], v[174:175], v[60:61] op_sel_hi:[1,0,1]
    v_lshlrev_b32 v226, 16, v135
    v_and_b32 v227, 0xffff0000, v135
    v_pk_fma_f32 v[62:63], v[226:227], v[174:175], v[62:63] op_sel_hi:[1,0,1]
    buffer_load_dwordx4 v[120:123], v223, s[48:51], s95 offen offset:0 sc1
    buffer_load_dwordx4 v[124:127], v223, s[48:51], s95 offen offset:1024 sc1
    buffer_load_dwordx4 v[128:131], v223, s[48:51], s95 offen offset:2048 sc1
    buffer_load_dwordx4 v[132:135], v223, s[48:51], s95 offen offset:3072 sc1
    s_waitcnt vmcnt(29)
    v_lshlrev_b32 v224, 16, v136
    v_and_b32 v225, 0xffff0000, v136
    v_pk_fma_f32 v[0:1], v[224:225], v[176:177], v[0:1] op_sel_hi:[1,0,1]
    v_lshlrev_b32 v226, 16, v137
    v_and_b32 v227, 0xffff0000, v137
    v_pk_fma_f32 v[2:3], v[226:227], v[176:177], v[2:3] op_sel_hi:[1,0,1]
    v_lshlrev_b32 v224, 16, v138
    v_and_b32 v225, 0xffff0000, v138
    v_pk_fma_f32 v[8:9], v[224:225], v[176:177], v[8:9] op_sel_hi:[1,0,1]
    v_lshlrev_b32 v226, 16, v139
    v_and_b32 v227, 0xffff0000, v139
    v_pk_fma_f32 v[10:11], v[226:227], v[176:177], v[10:11] op_sel_hi:[1,0,1]
    v_lshlrev_b32 v224, 16, v140
    v_and_b32 v225, 0xffff0000, v140
    v_pk_fma_f32 v[16:17], v[224:225], v[176:177], v[16:17] op_sel_hi:[1,0,1]
    v_lshlrev_b32 v226, 16, v141
    v_and_b32 v227, 0xffff0000, v141
    v_pk_fma_f32 v[18:19], v[226:227], v[176:177], v[18:19] op_sel_hi:[1,0,1]
    v_lshlrev_b32 v224, 16, v142
    v_and_b32 v225, 0xffff0000, v142
    v_pk_fma_f32 v[24:25], v[224:225], v[176:177], v[24:25] op_sel_hi:[1,0,1]
    v_lshlrev_b32 v226, 16, v143
    v_and_b32 v227, 0xffff0000, v143
    v_pk_fma_f32 v[26:27], v[226:227], v[176:177], v[26:27] op_sel_hi:[1,0,1]
    v_lshlrev_b32 v224, 16, v144
    v_and_b32 v225, 0xffff0000, v144
    v_pk_fma_f32 v[32:33], v[224:225], v[176:177], v[32:33] op_sel_hi:[1,0,1]
    v_lshlrev_b32 v226, 16, v145
    v_and_b32 v227, 0xffff0000, v145
    v_pk_fma_f32 v[34:35], v[226:227], v[176:177], v[34:35] op_sel_hi:[1,0,1]
    v_lshlrev_b32 v224, 16, v146
    v_and_b32 v225, 0xffff0000, v146
    v_pk_fma_f32 v[40:41], v[224:225], v[176:177], v[40:41] op_sel_hi:[1,0,1]
    v_lshlrev_b32 v226, 16, v147
    v_and_b32 v227, 0xffff0000, v147
    v_pk_fma_f32 v[42:43], v[226:227], v[176:177], v[42:43] op_sel_hi:[1,0,1]
    v_lshlrev_b32 v224, 16, v148
    v_and_b32 v225, 0xffff0000, v148
    v_pk_fma_f32 v[48:49], v[224:225], v[176:177], v[48:49] op_sel_hi:[1,0,1]
    v_lshlrev_b32 v226, 16, v149
    v_and_b32 v227, 0xffff0000, v149
    v_pk_fma_f32 v[50:51], v[226:227], v[176:177], v[50:51] op_sel_hi:[1,0,1]
    v_lshlrev_b32 v224, 16, v150
    v_and_b32 v225, 0xffff0000, v150
    v_pk_fma_f32 v[56:57], v[224:225], v[176:177], v[56:57] op_sel_hi:[1,0,1]
    v_lshlrev_b32 v226, 16, v151
    v_and_b32 v227, 0xffff0000, v151
    v_pk_fma_f32 v[58:59], v[226:227], v[176:177], v[58:59] op_sel_hi:[1,0,1]
    s_waitcnt vmcnt(25)
    v_lshlrev_b32 v224, 16, v152
    v_and_b32 v225, 0xffff0000, v152
    v_pk_fma_f32 v[4:5], v[224:225], v[178:179], v[4:5] op_sel_hi:[1,0,1]
    v_lshlrev_b32 v226, 16, v153
    v_and_b32 v227, 0xffff0000, v153
    v_pk_fma_f32 v[6:7], v[226:227], v[178:179], v[6:7] op_sel_hi:[1,0,1]
    v_lshlrev_b32 v224, 16, v154
    v_and_b32 v225, 0xffff0000, v154
    v_pk_fma_f32 v[12:13], v[224:225], v[178:179], v[12:13] op_sel_hi:[1,0,1]
    v_lshlrev_b32 v226, 16, v155
    v_and_b32 v227, 0xffff0000, v155
    v_pk_fma_f32 v[14:15], v[226:227], v[178:179], v[14:15] op_sel_hi:[1,0,1]
    v_lshlrev_b32 v224, 16, v156
    v_and_b32 v225, 0xffff0000, v156
    v_pk_fma_f32 v[20:21], v[224:225], v[178:179], v[20:21] op_sel_hi:[1,0,1]
    v_lshlrev_b32 v226, 16, v157
    v_and_b32 v227, 0xffff0000, v157
    v_pk_fma_f32 v[22:23], v[226:227], v[178:179], v[22:23] op_sel_hi:[1,0,1]
    v_lshlrev_b32 v224, 16, v158
    v_and_b32 v225, 0xffff0000, v158
    v_pk_fma_f32 v[28:29], v[224:225], v[178:179], v[28:29] op_sel_hi:[1,0,1]
    v_lshlrev_b32 v226, 16, v159
    v_and_b32 v227, 0xffff0000, v159
    v_pk_fma_f32 v[30:31], v[226:227], v[178:179], v[30:31] op_sel_hi:[1,0,1]
    v_lshlrev_b32 v224, 16, v160
    v_and_b32 v225, 0xffff0000, v160
    v_pk_fma_f32 v[36:37], v[224:225], v[178:179], v[36:37] op_sel_hi:[1,0,1]
    v_lshlrev_b32 v226, 16, v161
    v_and_b32 v227, 0xffff0000, v161
    v_pk_fma_f32 v[38:39], v[226:227], v[178:179], v[38:39] op_sel_hi:[1,0,1]
    v_lshlrev_b32 v224, 16, v162
    v_and_b32 v225, 0xffff0000, v162
    v_pk_fma_f32 v[44:45], v[224:225], v[178:179], v[44:45] op_sel_hi:[1,0,1]
    v_lshlrev_b32 v226, 16, v163
    v_and_b32 v227, 0xffff0000, v163
    v_pk_fma_f32 v[46:47], v[226:227], v[178:179], v[46:47] op_sel_hi:[1,0,1]
    v_lshlrev_b32 v224, 16, v164
    v_and_b32 v225, 0xffff0000, v164
    v_pk_fma_f32 v[52:53], v[224:225], v[178:179], v[52:53] op_sel_hi:[1,0,1]
    v_lshlrev_b32 v226, 16, v165
    v_and_b32 v227, 0xffff0000, v165
    v_pk_fma_f32 v[54:55], v[226:227], v[178:179], v[54:55] op_sel_hi:[1,0,1]
    v_lshlrev_b32 v224, 16, v166
    v_and_b32 v225, 0xffff0000, v166
    v_pk_fma_f32 v[60:61], v[224:225], v[178:179], v[60:61] op_sel_hi:[1,0,1]
    v_lshlrev_b32 v226, 16, v167
    v_and_b32 v227, 0xffff0000, v167
    v_pk_fma_f32 v[62:63], v[226:227], v[178:179], v[62:63] op_sel_hi:[1,0,1]
    s_cmp_gt_i32 s85, 3
    s_cbranch_scc0 L_rend
    s_waitcnt vmcnt(21)
    v_lshlrev_b32 v224, 16, v184
    v_and_b32 v225, 0xffff0000, v184
    v_pk_fma_f32 v[0:1], v[224:225], v[180:181], v[0:1] op_sel_hi:[1,0,1]
    v_lshlrev_b32 v226, 16, v185
    v_and_b32 v227, 0xffff0000, v185
    v_pk_fma_f32 v[2:3], v[226:227], v[180:181], v[2:3] op_sel_hi:[1,0,1]
    v_lshlrev_b32 v224, 16, v186
    v_and_b32 v225, 0xffff0000, v186
    v_pk_fma_f32 v[8:9], v[224:225], v[180:181], v[8:9] op_sel_hi:[1,0,1]
    v_lshlrev_b32 v226, 16, v187
    v_and_b32 v227, 0xffff0000, v187
    v_pk_fma_f32 v[10:11], v[226:227], v[180:181], v[10:11] op_sel_hi:[1,0,1]
    v_lshlrev_b32 v224, 16, v188
    v_and_b32 v225, 0xffff0000, v188
    v_pk_fma_f32 v[16:17], v[224:225], v[180:181], v[16:17] op_sel_hi:[1,0,1]
    v_lshlrev_b32 v226, 16, v189
    v_and_b32 v227, 0xffff0000, v189
    v_pk_fma_f32 v[18:19], v[226:227], v[180:181], v[18:19] op_sel_hi:[1,0,1]
    v_lshlrev_b32 v224, 16, v190
    v_and_b32 v225, 0xffff0000, v190
    v_pk_fma_f32 v[24:25], v[224:225], v[180:181], v[24:25] op_sel_hi:[1,0,1]
    v_lshlrev_b32 v226, 16, v191
    v_and_b32 v227, 0xffff0000, v191
    v_pk_fma_f32 v[26:27], v[226:227], v[180:181], v[26:27] op_sel_hi:[1,0,1]
    v_lshlrev_b32 v224, 16, v192
    v_and_b32 v225, 0xffff0000, v192
    v_pk_fma_f32 v[32:33], v[224:225], v[180:181], v[32:33] op_sel_hi:[1,0,1]
    v_lshlrev_b32 v226, 16, v193
    v_and_b32 v227, 0xffff0000, v193
    v_pk_fma_f32 v[34:35], v[226:227], v[180:181], v[34:35] op_sel_hi:[1,0,1]
    v_lshlrev_b32 v224, 16, v194
    v_and_b32 v225, 0xffff0000, v194
    v_pk_fma_f32 v[40:41], v[224:225], v[180:181], v[40:41] op_sel_hi:[1,0,1]
    v_lshlrev_b32 v226, 16, v195
    v_and_b32 v227, 0xffff0000, v195
    v_pk_fma_f32 v[42:43], v[226:227], v[180:181], v[42:43] op_sel_hi:[1,0,1]
    v_lshlrev_b32 v224, 16, v196
    v_and_b32 v225, 0xffff0000, v196
    v_pk_fma_f32 v[48:49], v[224:225], v[180:181], v[48:49] op_sel_hi:[1,0,1]
    v_lshlrev_b32 v226, 16, v197
    v_and_b32 v227, 0xffff0000, v197
    v_pk_fma_f32 v[50:51], v[226:227], v[180:181], v[50:51] op_sel_hi:[1,0,1]
    v_lshlrev_b32 v224, 16, v198
    v_and_b32 v225, 0xffff0000, v198
    v_pk_fma_f32 v[56:57], v[224:225], v[180:181], v[56:57] op_sel_hi:[1,0,1]
    v_lshlrev_b32 v226, 16, v199
    v_and_b32 v227, 0xffff0000, v199
    v_pk_fma_f32 v[58:59], v[226:227], v[180:181], v[58:59] op_sel_hi:[1,0,1]
    s_waitcnt vmcnt(17)
    v_lshlrev_b32 v224, 16, v200
    v_and_b32 v225, 0xffff0000, v200
    v_pk_fma_f32 v[4:5], v[224:225], v[182:183], v[4:5] op_sel_hi:[1,0,1]
    v_lshlrev_b32 v226, 16, v201
    v_and_b32 v227, 0xffff0000, v201
    v_pk_fma_f32 v[6:7], v[226:227], v[182:183], v[6:7] op_sel_hi:[1,0,1]
    v_lshlrev_b32 v224, 16, v202
    v_and_b32 v225, 0xffff0000, v202
    v_pk_fma_f32 v[12:13], v[224:225], v[182:183], v[12:13] op_sel_hi:[1,0,1]
    v_lshlrev_b32 v226, 16, v203
    v_and_b32 v227, 0xffff0000, v203
    v_pk_fma_f32 v[14:15], v[226:227], v[182:183], v[14:15] op_sel_hi:[1,0,1]
    v_lshlrev_b32 v224, 16, v204
    v_and_b32 v225, 0xffff0000, v204
    v_pk_fma_f32 v[20:21], v[224:225], v[182:183], v[20:21] op_sel_hi:[1,0,1]
    v_lshlrev_b32 v226, 16, v205
    v_and_b32 v227, 0xffff0000, v205
    v_pk_fma_f32 v[22:23], v[226:227], v[182:183], v[22:23] op_sel_hi:[1,0,1]
    v_lshlrev_b32 v224, 16, v206
    v_and_b32 v225, 0xffff0000, v206
    v_pk_fma_f32 v[28:29], v[224:225], v[182:183], v[28:29] op_sel_hi:[1,0,1]
    v_lshlrev_b32 v226, 16, v207
    v_and_b32 v227, 0xffff0000, v207
    v_pk_fma_f32 v[30:31], v[226:227], v[182:183], v[30:31] op_sel_hi:[1,0,1]
    v_lshlrev_b32 v224, 16, v208
    v_and_b32 v225, 0xffff0000, v208
    v_pk_fma_f32 v[36:37], v[224:225], v[182:183], v[36:37] op_sel_hi:[1,0,1]
    v_lshlrev_b32 v226, 16, v209
    v_and_b32 v227, 0xffff0000, v209
    v_pk_fma_f32 v[38:39], v[226:227], v[182:183], v[38:39] op_sel_hi:[1,0,1]
    v_lshlrev_b32 v224, 16, v210
    v_and_b32 v225, 0xffff0000, v210
    v_pk_fma_f32 v[44:45], v[224:225], v[182:183], v[44:45] op_sel_hi:[1,0,1]
    v_lshlrev_b32 v226, 16, v211
    v_and_b32 v227, 0xffff0000, v211
    v_pk_fma_f32 v[46:47], v[226:227], v[182:183], v[46:47] op_sel_hi:[1,0,1]
    v_lshlrev_b32 v224, 16, v212
    v_and_b32 v225, 0xffff0000, v212
    v_pk_fma_f32 v[52:53], v[224:225], v[182:183], v[52:53] op_sel_hi:[1,0,1]
    v_lshlrev_b32 v226, 16, v213
    v_and_b32 v227, 0xffff0000, v213
    v_pk_fma_f32 v[54:55], v[226:227], v[182:183], v[54:55] op_sel_hi:[1,0,1]
    v_lshlrev_b32 v224, 16, v214
    v_and_b32 v225, 0xffff0000, v214
    v_pk_fma_f32 v[60:61], v[224:225], v[182:183], v[60:61] op_sel_hi:[1,0,1]
    v_lshlrev_b32 v226, 16, v215
    v_and_b32 v227, 0xffff0000, v215
    v_pk_fma_f32 v[62:63], v[226:227], v[182:183], v[62:63] op_sel_hi:[1,0,1]
    s_cmp_gt_i32 s85, 4
    s_cbranch_scc0 L_rend
    s_waitcnt vmcnt(12)
    v_lshlrev_b32 v224, 16, v64
    v_and_b32 v225, 0xffff0000, v64
    v_pk_fma_f32 v[0:1], v[224:225], v[228:229], v[0:1] op_sel_hi:[1,0,1]
    v_lshlrev_b32 v226, 16, v65
    v_and_b32 v227, 0xffff0000, v65
    v_pk_fma_f32 v[2:3], v[226:227], v[228:229], v[2:3] op_sel_hi:[1,0,1]
    v_lshlrev_b32 v224, 16, v66
    v_and_b32 v225, 0xffff0000, v66
    v_pk_fma_f32 v[8:9], v[224:225], v[228:229], v[8:9] op_sel_hi:[1,0,1]
    v_lshlrev_b32 v226, 16, v67
    v_and_b32 v227, 0xffff0000, v67
    v_pk_fma_f32 v[10:11], v[226:227], v[228:229], v[10:11] op_sel_hi:[1,0,1]
    v_lshlrev_b32 v224, 16, v68
    v_and_b32 v225, 0xffff0000, v68
    v_pk_fma_f32 v[16:17], v[224:225], v[228:229], v[16:17] op_sel_hi:[1,0,1]
    v_lshlrev_b32 v226, 16, v69
    v_and_b32 v227, 0xffff0000, v69
    v_pk_fma_f32 v[18:19], v[226:227], v[228:229], v[18:19] op_sel_hi:[1,0,1]
    v_lshlrev_b32 v224, 16, v70
    v_and_b32 v225, 0xffff0000, v70
    v_pk_fma_f32 v[24:25], v[224:225], v[228:229], v[24:25] op_sel_hi:[1,0,1]
    v_lshlrev_b32 v226, 16, v71
    v_and_b32 v227, 0xffff0000, v71
    v_pk_fma_f32 v[26:27], v[226:227], v[228:229], v[26:27] op_sel_hi:[1,0,1]
    v_lshlrev_b32 v224, 16, v72
    v_and_b32 v225, 0xffff0000, v72
    v_pk_fma_f32 v[32:33], v[224:225], v[228:229], v[32:33] op_sel_hi:[1,0,1]
    v_lshlrev_b32 v226, 16, v73
    v_and_b32 v227, 0xffff0000, v73
    v_pk_fma_f32 v[34:35], v[226:227], v[228:229], v[34:35] op_sel_hi:[1,0,1]
    v_lshlrev_b32 v224, 16, v74
    v_and_b32 v225, 0xffff0000, v74
    v_pk_fma_f32 v[40:41], v[224:225], v[228:229], v[40:41] op_sel_hi:[1,0,1]
    v_lshlrev_b32 v226, 16, v75
    v_and_b32 v227, 0xffff0000, v75
    v_pk_fma_f32 v[42:43], v[226:227], v[228:229], v[42:43] op_sel_hi:[1,0,1]
    v_lshlrev_b32 v224, 16, v76
    v_and_b32 v225, 0xffff0000, v76
    v_pk_fma_f32 v[48:49], v[224:225], v[228:229], v[48:49] op_sel_hi:[1,0,1]
    v_lshlrev_b32 v226, 16, v77
    v_and_b32 v227, 0xffff0000, v77
    v_pk_fma_f32 v[50:51], v[226:227], v[228:229], v[50:51] op_sel_hi:[1,0,1]
    v_lshlrev_b32 v224, 16, v78
    v_and_b32 v225, 0xffff0000, v78
    v_pk_fma_f32 v[56:57], v[224:225], v[228:229], v[56:57] op_sel_hi:[1,0,1]
    v_lshlrev_b32 v226, 16, v79
    v_and_b32 v227, 0xffff0000, v79
    v_pk_fma_f32 v[58:59], v[226:227], v[228:229], v[58:59] op_sel_hi:[1,0,1]
    s_waitcnt vmcnt(8)
    v_lshlrev_b32 v224, 16, v80
    v_and_b32 v225, 0xffff0000, v80
    v_pk_fma_f32 v[4:5], v[224:225], v[230:231], v[4:5] op_sel_hi:[1,0,1]
    v_lshlrev_b32 v226, 16, v81
    v_and_b32 v227, 0xffff0000, v81
    v_pk_fma_f32 v[6:7], v[226:227], v[230:231], v[6:7] op_sel_hi:[1,0,1]
    v_lshlrev_b32 v224, 16, v82
    v_and_b32 v225, 0xffff0000, v82
    v_pk_fma_f32 v[12:13], v[224:225], v[230:231], v[12:13] op_sel_hi:[1,0,1]
    v_lshlrev_b32 v226, 16, v83
    v_and_b32 v227, 0xffff0000, v83
    v_pk_fma_f32 v[14:15], v[226:227], v[230:231], v[14:15] op_sel_hi:[1,0,1]
    v_lshlrev_b32 v224, 16, v84
    v_and_b32 v225, 0xffff0000, v84
    v_pk_fma_f32 v[20:21], v[224:225], v[230:231], v[20:21] op_sel_hi:[1,0,1]
    v_lshlrev_b32 v226, 16, v85
    v_and_b32 v227, 0xffff0000, v85
    v_pk_fma_f32 v[22:23], v[226:227], v[230:231], v[22:23] op_sel_hi:[1,0,1]
    v_lshlrev_b32 v224, 16, v86
    v_and_b32 v225, 0xffff0000, v86
    v_pk_fma_f32 v[28:29], v[224:225], v[230:231], v[28:29] op_sel_hi:[1,0,1]
    v_lshlrev_b32 v226, 16, v87
    v_and_b32 v227, 0xffff0000, v87
    v_pk_fma_f32 v[30:31], v[226:227], v[230:231], v[30:31] op_sel_hi:[1,0,1]
    v_lshlrev_b32 v224, 16, v88
    v_and_b32 v225, 0xffff0000, v88
    v_pk_fma_f32 v[36:37], v[224:225], v[230:231], v[36:37] op_sel_hi:[1,0,1]
    v_lshlrev_b32 v226, 16, v89
    v_and_b32 v227, 0xffff0000, v89
    v_pk_fma_f32 v[38:39], v[226:227], v[230:231], v[38:39] op_sel_hi:[1,0,1]
    v_lshlrev_b32 v224, 16, v90
    v_and_b32 v225, 0xffff0000, v90
    v_pk_fma_f32 v[44:45], v[224:225], v[230:231], v[44:45] op_sel_hi:[1,0,1]
    v_lshlrev_b32 v226, 16, v91
    v_and_b32 v227, 0xffff0000, v91
    v_pk_fma_f32 v[46:47], v[226:227], v[230:231], v[46:47] op_sel_hi:[1,0,1]
    v_lshlrev_b32 v224, 16, v92
    v_and_b32 v225, 0xffff0000, v92
    v_pk_fma_f32 v[52:53], v[224:225], v[230:231], v[52:53] op_sel_hi:[1,0,1]
    v_lshlrev_b32 v226, 16, v93
    v_and_b32 v227, 0xffff0000, v93
    v_pk_fma_f32 v[54:55], v[226:227], v[230:231], v[54:55] op_sel_hi:[1,0,1]
    v_lshlrev_b32 v224, 16, v94
    v_and_b32 v225, 0xffff0000, v94
    v_pk_fma_f32 v[60:61], v[224:225], v[230:231], v[60:61] op_sel_hi:[1,0,1]
    v_lshlrev_b32 v226, 16, v95
    v_and_b32 v227, 0xffff0000, v95
    v_pk_fma_f32 v[62:63], v[226:227], v[230:231], v[62:63] op_sel_hi:[1,0,1]
    s_cmp_gt_i32 s85, 5
    s_cbranch_scc0 L_rend
    s_waitcnt vmcnt(4)
    v_lshlrev_b32 v224, 16, v104
    v_and_b32 v225, 0xffff0000, v104
    v_pk_fma_f32 v[0:1], v[224:225], v[232:233], v[0:1] op_sel_hi:[1,0,1]
    v_lshlrev_b32 v226, 16, v105
    v_and_b32 v227, 0xffff0000, v105
    v_pk_fma_f32 v[2:3], v[226:227], v[232:233], v[2:3] op_sel_hi:[1,0,1]
    v_lshlrev_b32 v224, 16, v106
    v_and_b32 v225, 0xffff0000, v106
    v_pk_fma_f32 v[8:9], v[224:225], v[232:233], v[8:9] op_sel_hi:[1,0,1]
    v_lshlrev_b32 v226, 16, v107
    v_and_b32 v227, 0xffff0000, v107
    v_pk_fma_f32 v[10:11], v[226:227], v[232:233], v[10:11] op_sel_hi:[1,0,1]
    v_lshlrev_b32 v224, 16, v108
    v_and_b32 v225, 0xffff0000, v108
    v_pk_fma_f32 v[16:17], v[224:225], v[232:233], v[16:17] op_sel_hi:[1,0,1]
    v_lshlrev_b32 v226, 16, v109
    v_and_b32 v227, 0xffff0000, v109
    v_pk_fma_f32 v[18:19], v[226:227], v[232:233], v[18:19] op_sel_hi:[1,0,1]
    v_lshlrev_b32 v224, 16, v110
    v_and_b32 v225, 0xffff0000, v110
    v_pk_fma_f32 v[24:25], v[224:225], v[232:233], v[24:25] op_sel_hi:[1,0,1]
    v_lshlrev_b32 v226, 16, v111
    v_and_b32 v227, 0xffff0000, v111
    v_pk_fma_f32 v[26:27], v[226:227], v[232:233], v[26:27] op_sel_hi:[1,0,1]
    v_lshlrev_b32 v224, 16, v112
    v_and_b32 v225, 0xffff0000, v112
    v_pk_fma_f32 v[32:33], v[224:225], v[232:233], v[32:33] op_sel_hi:[1,0,1]
    v_lshlrev_b32 v226, 16, v113
    v_and_b32 v227, 0xffff0000, v113
    v_pk_fma_f32 v[34:35], v[226:227], v[232:233], v[34:35] op_sel_hi:[1,0,1]
    v_lshlrev_b32 v224, 16, v114
    v_and_b32 v225, 0xffff0000, v114
    v_pk_fma_f32 v[40:41], v[224:225], v[232:233], v[40:41] op_sel_hi:[1,0,1]
    v_lshlrev_b32 v226, 16, v115
    v_and_b32 v227, 0xffff0000, v115
    v_pk_fma_f32 v[42:43], v[226:227], v[232:233], v[42:43] op_sel_hi:[1,0,1]
    v_lshlrev_b32 v224, 16, v116
    v_and_b32 v225, 0xffff0000, v116
    v_pk_fma_f32 v[48:49], v[224:225], v[232:233], v[48:49] op_sel_hi:[1,0,1]
    v_lshlrev_b32 v226, 16, v117
    v_and_b32 v227, 0xffff0000, v117
    v_pk_fma_f32 v[50:51], v[226:227], v[232:233], v[50:51] op_sel_hi:[1,0,1]
    v_lshlrev_b32 v224, 16, v118
    v_and_b32 v225, 0xffff0000, v118
    v_pk_fma_f32 v[56:57], v[224:225], v[232:233], v[56:57] op_sel_hi:[1,0,1]
    v_lshlrev_b32 v226, 16, v119
    v_and_b32 v227, 0xffff0000, v119
    v_pk_fma_f32 v[58:59], v[226:227], v[232:233], v[58:59] op_sel_hi:[1,0,1]
    s_waitcnt vmcnt(0)
    v_lshlrev_b32 v224, 16, v120
    v_and_b32 v225, 0xffff0000, v120
    v_pk_fma_f32 v[4:5], v[224:225], v[234:235], v[4:5] op_sel_hi:[1,0,1]
    v_lshlrev_b32 v226, 16, v121
    v_and_b32 v227, 0xffff0000, v121
    v_pk_fma_f32 v[6:7], v[226:227], v[234:235], v[6:7] op_sel_hi:[1,0,1]
    v_lshlrev_b32 v224, 16, v122
    v_and_b32 v225, 0xffff0000, v122
    v_pk_fma_f32 v[12:13], v[224:225], v[234:235], v[12:13] op_sel_hi:[1,0,1]
    v_lshlrev_b32 v226, 16, v123
    v_and_b32 v227, 0xffff0000, v123
    v_pk_fma_f32 v[14:15], v[226:227], v[234:235], v[14:15] op_sel_hi:[1,0,1]
    v_lshlrev_b32 v224, 16, v124
    v_and_b32 v225, 0xffff0000, v124
    v_pk_fma_f32 v[20:21], v[224:225], v[234:235], v[20:21] op_sel_hi:[1,0,1]
    v_lshlrev_b32 v226, 16, v125
    v_and_b32 v227, 0xffff0000, v125
    v_pk_fma_f32 v[22:23], v[226:227], v[234:235], v[22:23] op_sel_hi:[1,0,1]
    v_lshlrev_b32 v224, 16, v126
    v_and_b32 v225, 0xffff0000, v126
    v_pk_fma_f32 v[28:29], v[224:225], v[234:235], v[28:29] op_sel_hi:[1,0,1]
    v_lshlrev_b32 v226, 16, v127
    v_and_b32 v227, 0xffff0000, v127
    v_pk_fma_f32 v[30:31], v[226:227], v[234:235], v[30:31] op_sel_hi:[1,0,1]
    v_lshlrev_b32 v224, 16, v128
    v_and_b32 v225, 0xffff0000, v128
    v_pk_fma_f32 v[36:37], v[224:225], v[234:235], v[36:37] op_sel_hi:[1,0,1]
    v_lshlrev_b32 v226, 16, v129
    v_and_b32 v227, 0xffff0000, v129
    v_pk_fma_f32 v[38:39], v[226:227], v[234:235], v[38:39] op_sel_hi:[1,0,1]
    v_lshlrev_b32 v224, 16, v130
    v_and_b32 v225, 0xffff0000, v130
    v_pk_fma_f32 v[44:45], v[224:225], v[234:235], v[44:45] op_sel_hi:[1,0,1]
    v_lshlrev_b32 v226, 16, v131
    v_and_b32 v227, 0xffff0000, v131
    v_pk_fma_f32 v[46:47], v[226:227], v[234:235], v[46:47] op_sel_hi:[1,0,1]
    v_lshlrev_b32 v224, 16, v132
    v_and_b32 v225, 0xffff0000, v132
    v_pk_fma_f32 v[52:53], v[224:225], v[234:235], v[52:53] op_sel_hi:[1,0,1]
    v_lshlrev_b32 v226, 16, v133
    v_and_b32 v227, 0xffff0000, v133
    v_pk_fma_f32 v[54:55], v[226:227], v[234:235], v[54:55] op_sel_hi:[1,0,1]
    v_lshlrev_b32 v224, 16, v134
    v_and_b32 v225, 0xffff0000, v134
    v_pk_fma_f32 v[60:61], v[224:225], v[234:235], v[60:61] op_sel_hi:[1,0,1]
    v_lshlrev_b32 v226, 16, v135
    v_and_b32 v227, 0xffff0000, v135
    v_pk_fma_f32 v[62:63], v[226:227], v[234:235], v[62:63] op_sel_hi:[1,0,1]
L_rend:
    s_cmp_eq_u64 s[86:87], 0
    s_cbranch_scc1 L_out
    s_mov_b64 exec, s[86:87]
    s_branch L_poll
L_out:
    v_rcp_f32 v218, v248
    v_rcp_f32 v220, v252
    s_lshl_b32 s32, s14, 3
    s_add_u32 s32, s32, s4
    s_lshl_b32 s32, s32, 2
    s_add_u32 s32, s32, s6
    s_lshl_b32 s32, s32, 13
    s_add_u32 s33, s32, 4096
    v_and_b32 v250, 15, v251
    v_lshlrev_b32 v250, 8, v250
    v_bfe_u32 v249, v251, 4, 1
    v_lshl_add_u32 v250, v249, 5, v250
    v_lshrrev_b32 v249, 5, v251
    v_lshl_add_u32 v250, v249, 4, v250
    s_waitcnt vmcnt(0)
    v_pk_mul_f32 v[0:1], v[0:1], v[218:219] op_sel_hi:[1,0]
    v_pk_mul_f32 v[2:3], v[2:3], v[218:219] op_sel_hi:[1,0]
    v_pk_mul_f32 v[4:5], v[4:5], v[220:221] op_sel_hi:[1,0]
    v_pk_mul_f32 v[6:7], v[6:7], v[220:221] op_sel_hi:[1,0]
    v_pk_mul_f32 v[8:9], v[8:9], v[218:219] op_sel_hi:[1,0]
    v_pk_mul_f32 v[10:11], v[10:11], v[218:219] op_sel_hi:[1,0]
    v_pk_mul_f32 v[12:13], v[12:13], v[220:221] op_sel_hi:[1,0]
    v_pk_mul_f32 v[14:15], v[14:15], v[220:221] op_sel_hi:[1,0]
    v_pk_mul_f32 v[16:17], v[16:17], v[218:219] op_sel_hi:[1,0]
    v_pk_mul_f32 v[18:19], v[18:19], v[218:219] op_sel_hi:[1,0]
    v_pk_mul_f32 v[20:21], v[20:21], v[220:221] op_sel_hi:[1,0]
    v_pk_mul_f32 v[22:23], v[22:23], v[220:221] op_sel_hi:[1,0]
    v_pk_mul_f32 v[24:25], v[24:25], v[218:219] op_sel_hi:[1,0]
    v_pk_mul_f32 v[26:27], v[26:27], v[218:219] op_sel_hi:[1,0]
    v_pk_mul_f32 v[28:29], v[28:29], v[220:221] op_sel_hi:[1,0]
    v_pk_mul_f32 v[30:31], v[30:31], v[220:221] op_sel_hi:[1,0]
    v_pk_mul_f32 v[32:33], v[32:33], v[218:219] op_sel_hi:[1,0]
    v_pk_mul_f32 v[34:35], v[34:35], v[218:219] op_sel_hi:[1,0]
    v_pk_mul_f32 v[36:37], v[36:37], v[220:221] op_sel_hi:[1,0]
    v_pk_mul_f32 v[38:39], v[38:39], v[220:221] op_sel_hi:[1,0]
    v_pk_mul_f32 v[40:41], v[40:41], v[218:219] op_sel_hi:[1,0]
    v_pk_mul_f32 v[42:43], v[42:43], v[218:219] op_sel_hi:[1,0]
    v_pk_mul_f32 v[44:45], v[44:45], v[220:221] op_sel_hi:[1,0]
    v_pk_mul_f32 v[46:47], v[46:47], v[220:221] op_sel_hi:[1,0]
    v_pk_mul_f32 v[48:49], v[48:49], v[218:219] op_sel_hi:[1,0]
    v_pk_mul_f32 v[50:51], v[50:51], v[218:219] op_sel_hi:[1,0]
    v_pk_mul_f32 v[52:53], v[52:53], v[220:221] op_sel_hi:[1,0]
    v_pk_mul_f32 v[54:55], v[54:55], v[220:221] op_sel_hi:[1,0]
    v_pk_mul_f32 v[56:57], v[56:57], v[218:219] op_sel_hi:[1,0]
    v_pk_mul_f32 v[58:59], v[58:59], v[218:219] op_sel_hi:[1,0]
    v_pk_mul_f32 v[60:61], v[60:61], v[220:221] op_sel_hi:[1,0]
    v_pk_mul_f32 v[62:63], v[62:63], v[220:221] op_sel_hi:[1,0]
    v_cvt_pk_bf16_f32 v184, v0, v1
    v_cvt_pk_bf16_f32 v185, v2, v3
    v_cvt_pk_bf16_f32 v186, v8, v9
    v_cvt_pk_bf16_f32 v187, v10, v11
    v_cvt_pk_bf16_f32 v188, v16, v17
    v_cvt_pk_bf16_f32 v189, v18, v19
    v_cvt_pk_bf16_f32 v190, v24, v25
    v_cvt_pk_bf16_f32 v191, v26, v27
    v_permlane16_swap_b32 v184, v186
    v_permlane16_swap_b32 v185, v187
    v_cvt_pk_bf16_f32 v192, v32, v33
    v_cvt_pk_bf16_f32 v193, v34, v35
    v_cvt_pk_bf16_f32 v194, v40, v41
    v_cvt_pk_bf16_f32 v195, v42, v43
    v_permlane16_swap_b32 v188, v190
    v_permlane16_swap_b32 v189, v191
    buffer_store_dwordx4 v[184:187], v250, s[64:67], s32 offen offset:0 sc1
    v_cvt_pk_bf16_f32 v196, v48, v49
    v_cvt_pk_bf16_f32 v197, v50, v51
    v_cvt_pk_bf16_f32 v198, v56, v57
    v_cvt_pk_bf16_f32 v199, v58, v59
    v_permlane16_swap_b32 v192, v194
    v_permlane16_swap_b32 v193, v195
    buffer_store_dwordx4 v[188:191], v250, s[64:67], s32 offen offset:64 sc1
    v_cvt_pk_bf16_f32 v200, v4, v5
    v_cvt_pk_bf16_f32 v201, v6, v7
    v_cvt_pk_bf16_f32 v202, v12, v13
    v_cvt_pk_bf16_f32 v203, v14, v15
    v_permlane16_swap_b32 v196, v198
    v_permlane16_swap_b32 v197, v199
    buffer_store_dwordx4 v[192:195], v250, s[64:67], s32 offen offset:128 sc1
    v_cvt_pk_bf16_f32 v204, v20, v21
    v_cvt_pk_bf16_f32 v205, v22, v23
    v_cvt_pk_bf16_f32 v206, v28, v29
    v_cvt_pk_bf16_f32 v207, v30, v31
    v_permlane16_swap_b32 v200, v202
    v_permlane16_swap_b32 v201, v203
    buffer_store_dwordx4 v[196:199], v250, s[64:67], s32 offen offset:192 sc1
    v_cvt_pk_bf16_f32 v208, v36, v37
    v_cvt_pk_bf16_f32 v209, v38, v39
    v_cvt_pk_bf16_f32 v210, v44, v45
    v_cvt_pk_bf16_f32 v211, v46, v47
    v_permlane16_swap_b32 v204, v206
    v_permlane16_swap_b32 v205, v207
    buffer_store_dwordx4 v[200:203], v250, s[64:67], s33 offen offset:0 sc1
    v_cvt_pk_bf16_f32 v212, v52, v53
    v_cvt_pk_bf16_f32 v213, v54, v55
    v_cvt_pk_bf16_f32 v214, v60, v61
    v_cvt_pk_bf16_f32 v215, v62, v63
    v_permlane16_swap_b32 v208, v210
    v_permlane16_swap_b32 v209, v211
    buffer_store_dwordx4 v[204:207], v250, s[64:67], s33 offen offset:64 sc1
    s_nop 1
    v_permlane16_swap_b32 v212, v214
    v_permlane16_swap_b32 v213, v215
    buffer_store_dwordx4 v[208:211], v250, s[64:67], s33 offen offset:128 sc1
    buffer_store_dwordx4 v[212:215], v250, s[64:67], s33 offen offset:192 sc1
    s_cmp_lt_u32 s9, s8
    s_cbranch_scc1 L_next
L_done:
L_end:
    s_endpgm
L_idle:
    s_or_b32 s3, s5, s6
    s_cbranch_scc1 L_nopubb
    v_mov_b32 v4, 1
    s_mov_b64 exec, 1
    s_waitcnt vmcnt(0)
    buffer_store_dword v4, off, s[40:43], s91 sc1
    s_mov_b64 exec, -1
L_nopubb:
    s_endpgm
L_loader:
    s_setprio 1
    s_mov_b32 s52, s22
    s_and_b32 s53, s23, 0xffff
    s_mov_b32 s54, 0x4000
    s_mov_b32 s55, 0x20000
    s_and_b32 s3, s6, 3
    s_lshl_b32 s3, s3, 12
    s_add_u32 m0, s3, 98304
    v_lshlrev_b32 v1, 4, v251
    buffer_load_dwordx4 v1, s[52:55], s3 offen offset:0 lds
    buffer_load_dwordx4 v1, s[52:55], s3 offen offset:1024 lds
    buffer_load_dwordx4 v1, s[52:55], s3 offen offset:2048 lds
    buffer_load_dwordx4 v1, s[52:55], s3 offen offset:3072 lds
    s_mov_b32 s40, s18
    s_and_b32 s41, s19, 0xffff
    s_mov_b32 s42, 0x8020000
    s_mov_b32 s43, 0x20000
    s_mov_b32 s44, s20
    s_and_b32 s45, s21, 0xffff
    s_mov_b32 s46, 0x8020000
    s_mov_b32 s47, 0x20000
    s_lshr_b32 s32, s18, 8
    s_add_u32 s32, s32, s4
    s_and_b32 s32, s32, 7
    s_lshl_b32 s32, s32, 2
    s_lshr_b32 s14, 0x22422242, s32
    s_and_b32 s14, s14, 15
    s_and_b32 s32, s6, 1
    s_lshl_b32 s32, s32, 3
    s_lshl_b32 s33, s4, 8
    v_lshrrev_b32 v248, 4, v251
    v_add_u32 v249, s32, v248
    v_and_b32 v250, 15, v251
    v_xor_b32 v9, v250, v249
    v_lshlrev_b32 v9, 4, v9
    v_lshl_add_u32 v9, v249, 11, v9
    v_add_u32 v1, s33, v9
    v_xor_b32 v2, 64, v1
    v_add_u32 v2, 7168, v2
    v_lshlrev_b32 v248, 1, v248
    v_xor_b32 v248, s32, v248
    v_xor_b32 v9, v250, v248
    v_lshlrev_b32 v9, 4, v9
    v_lshl_add_u32 v9, v249, 11, v9
    v_add_u32 v3, s33, v9
    v_xor_b32 v4, 128, v3
    v_add_u32 v4, 7168, v4
    s_and_b32 s6, s6, 3
    s_lshl_b32 s10, s6, 11
    s_add_u32 s11, s10, 90112
    s_waitcnt lgkmcnt(0)
    s_mov_b32 s76, 0
    s_sub_u32 s68, 0, s56
    s_max_u32 s68, s68, 0xffffe000
    s_ashr_i32 s3, s68, 5
    s_sub_u32 s68, 0, s68
    s_sub_u32 s77, s76, s3
    s_sub_u32 s69, 0, s57
    s_max_u32 s69, s69, 0xffffe000
    s_ashr_i32 s3, s69, 5
    s_sub_u32 s69, 0, s69
    s_sub_u32 s78, s77, s3
    s_sub_u32 s70, 0, s58
    s_max_u32 s70, s70, 0xffffe000
    s_ashr_i32 s3, s70, 5
    s_sub_u32 s70, 0, s70
    s_sub_u32 s79, s78, s3
    s_sub_u32 s71, 0, s59
    s_max_u32 s71, s71, 0xffffe000
    s_ashr_i32 s3, s71, 5
    s_sub_u32 s71, 0, s71
    s_sub_u32 s80, s79, s3
    s_sub_u32 s72, 0, s60
    s_max_u32 s72, s72, 0xffffe000
    s_ashr_i32 s3, s72, 5
    s_sub_u32 s72, 0, s72
    s_sub_u32 s81, s80, s3
    s_sub_u32 s73, 0, s61
    s_max_u32 s73, s73, 0xffffe000
    s_ashr_i32 s3, s73, 5
    s_sub_u32 s73, 0, s73
    s_sub_u32 s82, s81, s3
    s_sub_u32 s74, 0, s62
    s_max_u32 s74, s74, 0xffffe000
    s_ashr_i32 s3, s74, 5
    s_sub_u32 s74, 0, s74
    s_sub_u32 s83, s82, s3
    s_sub_u32 s75, 0, s63
    s_max_u32 s75, s75, 0xffffe000
    s_ashr_i32 s3, s75, 5
    s_sub_u32 s75, 0, s75
    s_sub_u32 s84, s83, s3
    s_add_u32 s32, s84, 7
    s_mul_i32 s32, s32, s35
    s_mul_i32 s7, s5, s32
    s_add_u32 s8, s7, s32
    s_lshr_b32 s7, s7, 17
    s_lshr_b32 s8, s8, 17
    s_cmp_gt_u32 s7, s77
    s_subb_u32 s7, s7, 0
    s_cmp_gt_u32 s8, s77
    s_subb_u32 s8, s8, 0
    s_cmp_gt_u32 s7, s78
    s_subb_u32 s7, s7, 0
    s_cmp_gt_u32 s8, s78
    s_subb_u32 s8, s8, 0
    s_cmp_gt_u32 s7, s79
    s_subb_u32 s7, s7, 0
    s_cmp_gt_u32 s8, s79
    s_subb_u32 s8, s8, 0
    s_cmp_gt_u32 s7, s80
    s_subb_u32 s7, s7, 0
    s_cmp_gt_u32 s8, s80
    s_subb_u32 s8, s8, 0
    s_cmp_gt_u32 s7, s81
    s_subb_u32 s7, s7, 0
    s_cmp_gt_u32 s8, s81
    s_subb_u32 s8, s8, 0
    s_cmp_gt_u32 s7, s82
    s_subb_u32 s7, s7, 0
    s_cmp_gt_u32 s8, s82
    s_subb_u32 s8, s8, 0
    s_cmp_gt_u32 s7, s83
    s_subb_u32 s7, s7, 0
    s_cmp_gt_u32 s8, s83
    s_subb_u32 s8, s8, 0
    s_sub_u32 s8, s8, s7
    s_cmp_eq_u32 s8, 0
    s_cbranch_scc1 L_lidle
    s_lshr_b32 s15, s6, 1
    s_mov_b32 s9, 0
    s_mov_b32 s12, 0x80000000
    v_add_u32 v9, 0, v251
    v_add_u32 v248, s7, v9
    v_mov_b32 v6, 0
    v_mov_b32 v7, s68
    v_mov_b32 v8, 0
    v_cmpx_le_u32 vcc, s77, v248
    v_mov_b32 v7, s69
    v_mov_b32 v8, s77
    v_mov_b32 v6, 2048
    v_cmpx_le_u32 vcc, s78, v248
    v_mov_b32 v7, s70
    v_mov_b32 v8, s78
    v_mov_b32 v6, 4096
    v_cmpx_le_u32 vcc, s79, v248
    v_mov_b32 v7, s71
    v_mov_b32 v8, s79
    v_mov_b32 v6, 6144
    v_cmpx_le_u32 vcc, s80, v248
    v_mov_b32 v7, s72
    v_mov_b32 v8, s80
    v_mov_b32 v6, 8192
    v_cmpx_le_u32 vcc, s81, v248
    v_mov_b32 v7, s73
    v_mov_b32 v8, s81
    v_mov_b32 v6, 10240
    v_cmpx_le_u32 vcc, s82, v248
    v_mov_b32 v7, s74
    v_mov_b32 v8, s82
    v_mov_b32 v6, 12288
    v_cmpx_le_u32 vcc, s83, v248
    v_mov_b32 v7, s75
    v_mov_b32 v8, s83
    v_mov_b32 v6, 14336
    s_mov_b64 exec, -1
    v_sub_u32 v248, v248, v8
    v_lshl_add_u32 v248, v248, 1, s15
    v_lshl_add_u32 v249, v248, 2, v6
    v_min_u32 v249, 16380, v249
    s_waitcnt vmcnt(0)
    s_barrier
    v_add_u32 v249, 98304, v249
    ds_read_b32 v5, v249
    v_lshlrev_b32 v248, 4, v248
    v_cmp_lt_u32 s[94:95], v248, v7
    v_cmp_gt_u32 vcc, s8, v9
    v_mov_b32 v248, 0x80000000
    s_and_b64 s[94:95], s[94:95], vcc
    s_waitcnt lgkmcnt(0)
    v_lshlrev_b32 v5, 15, v5
    v_cndmask_b32 v5, v248, v5, s[94:95]
    s_mov_b32 s13, s12
    v_readlane_b32 s12, v5, s9
    v_readlane_b32 s3, v10, s9
    s_cmp_lt_u32 s9, 64
    s_cselect_b32 s12, s12, s3
    s_add_u32 s9, s9, 1
    s_nop 1
    s_mov_b32 m0, s10
    s_add_u32 s10, s10, 8192
    buffer_load_dwordx4 v1, s[40:43], s12 offen nt lds
    buffer_load_dwordx4 v2, s[40:43], s12 offen offset:1024 nt lds
    s_mov_b32 m0, s11
    s_add_u32 s11, s11, 8192
    s_cmp_ge_u32 s10, 49152
    s_cselect_b32 s32, 49152, 0
    s_sub_u32 s10, s10, s32
    s_cmp_ge_u32 s11, 98304
    s_cselect_b32 s32, 49152, 0
    s_sub_u32 s11, s11, s32
    s_mov_b32 s13, s12
    v_readlane_b32 s12, v5, s9
    v_readlane_b32 s3, v10, s9
    s_cmp_lt_u32 s9, 64
    s_cselect_b32 s12, s12, s3
    s_add_u32 s9, s9, 1
    s_nop 1
    s_mov_b32 m0, s10
    s_add_u32 s10, s10, 8192
    buffer_load_dwordx4 v1, s[40:43], s12 offen nt lds
    buffer_load_dwordx4 v2, s[40:43], s12 offen offset:1024 nt lds
    s_mov_b32 m0, s11
    s_add_u32 s11, s11, 8192
    buffer_load_dwordx4 v3, s[44:47], s13 offen nt lds
    buffer_load_dwordx4 v4, s[44:47], s13 offen offset:1024 nt lds
    s_cmp_ge_u32 s10, 49152
    s_cselect_b32 s32, 49152, 0
    s_sub_u32 s10, s10, s32
    s_cmp_ge_u32 s11, 98304
    s_cselect_b32 s32, 49152, 0
    s_sub_u32 s11, s11, s32
    s_cmp_eq_u32 s14, 2
    s_cbranch_scc1 L_pre2
    s_mov_b32 s13, s12
    v_readlane_b32 s12, v5, s9
    v_readlane_b32 s3, v10, s9
    s_cmp_lt_u32 s9, 64
    s_cselect_b32 s12, s12, s3
    s_add_u32 s9, s9, 1
    s_nop 1
    s_mov_b32 m0, s10
    s_add_u32 s10, s10, 8192
    buffer_load_dwordx4 v1, s[40:43], s12 offen nt lds
    buffer_load_dwordx4 v2, s[40:43], s12 offen offset:1024 nt lds
    s_mov_b32 m0, s11
    s_add_u32 s11, s11, 8192
    buffer_load_dwordx4 v3, s[44:47], s13 offen nt lds
    buffer_load_dwordx4 v4, s[44:47], s13 offen offset:1024 nt lds
    s_cmp_ge_u32 s10, 49152
    s_cselect_b32 s32, 49152, 0
    s_sub_u32 s10, s10, s32
    s_cmp_ge_u32 s11, 98304
    s_cselect_b32 s32, 49152, 0
    s_sub_u32 s11, s11, s32
    s_mov_b32 s13, s12
    v_readlane_b32 s12, v5, s9
    v_readlane_b32 s3, v10, s9
    s_cmp_lt_u32 s9, 64
    s_cselect_b32 s12, s12, s3
    s_add_u32 s9, s9, 1
    s_nop 1
    s_mov_b32 m0, s10
    s_add_u32 s10, s10, 8192
    buffer_load_dwordx4 v1, s[40:43], s12 offen nt lds
    buffer_load_dwordx4 v2, s[40:43], s12 offen offset:1024 nt lds
    s_mov_b32 m0, s11
    s_add_u32 s11, s11, 8192
    buffer_load_dwordx4 v3, s[44:47], s13 offen nt lds
    buffer_load_dwordx4 v4, s[44:47], s13 offen offset:1024 nt lds
    s_cmp_ge_u32 s10, 49152
    s_cselect_b32 s32, 49152, 0
    s_sub_u32 s10, s10, s32
    s_cmp_ge_u32 s11, 98304
    s_cselect_b32 s32, 49152, 0
    s_sub_u32 s11, s11, s32
L_pre4:
    v_add_u32 v9, 64, v251
    v_add_u32 v248, s7, v9
    v_mov_b32 v6, 0
    v_mov_b32 v7, s68
    v_mov_b32 v8, 0
    v_cmpx_le_u32 vcc, s77, v248
    v_mov_b32 v7, s69
    v_mov_b32 v8, s77
    v_mov_b32 v6, 2048
    v_cmpx_le_u32 vcc, s78, v248
    v_mov_b32 v7, s70
    v_mov_b32 v8, s78
    v_mov_b32 v6, 4096
    v_cmpx_le_u32 vcc, s79, v248
    v_mov_b32 v7, s71
    v_mov_b32 v8, s79
    v_mov_b32 v6, 6144
    v_cmpx_le_u32 vcc, s80, v248
    v_mov_b32 v7, s72
    v_mov_b32 v8, s80
    v_mov_b32 v6, 8192
    v_cmpx_le_u32 vcc, s81, v248
    v_mov_b32 v7, s73
    v_mov_b32 v8, s81
    v_mov_b32 v6, 10240
    v_cmpx_le_u32 vcc, s82, v248
    v_mov_b32 v7, s74
    v_mov_b32 v8, s82
    v_mov_b32 v6, 12288
    v_cmpx_le_u32 vcc, s83, v248
    v_mov_b32 v7, s75
    v_mov_b32 v8, s83
    v_mov_b32 v6, 14336
    s_mov_b64 exec, -1
    v_sub_u32 v248, v248, v8
    v_lshl_add_u32 v248, v248, 1, s15
    v_lshl_add_u32 v249, v248, 2, v6
    v_min_u32 v249, 16380, v249
    v_add_u32 v249, 98304, v249
    ds_read_b32 v10, v249
    v_lshlrev_b32 v248, 4, v248
    v_cmp_lt_u32 s[94:95], v248, v7
    v_cmp_gt_u32 vcc, s8, v9
    v_mov_b32 v248, 0x80000000
    s_and_b64 s[94:95], s[94:95], vcc
    s_waitcnt lgkmcnt(0)
    v_lshlrev_b32 v10, 15, v10
    v_cndmask_b32 v10, v248, v10, s[94:95]
    s_add_u32 s8, s8, 5
    s_mov_b32 s13, s12
    v_readlane_b32 s12, v5, s9
    v_readlane_b32 s3, v10, s9
    s_cmp_lt_u32 s9, 64
    s_cselect_b32 s12, s12, s3
    s_add_u32 s9, s9, 1
L_ld4:
    s_waitcnt vmcnt(12)
    s_barrier
    s_mov_b32 m0, s10
    s_add_u32 s10, s10, 8192
    buffer_load_dwordx4 v1, s[40:43], s12 offen nt lds
    buffer_load_dwordx4 v2, s[40:43], s12 offen offset:1024 nt lds
    s_mov_b32 m0, s11
    s_add_u32 s11, s11, 8192
    buffer_load_dwordx4 v3, s[44:47], s13 offen nt lds
    buffer_load_dwordx4 v4, s[44:47], s13 offen offset:1024 nt lds
    s_cmp_ge_u32 s10, 49152
    s_cselect_b32 s32, 49152, 0
    s_sub_u32 s10, s10, s32
    s_cmp_ge_u32 s11, 98304
    s_cselect_b32 s32, 49152, 0
    s_sub_u32 s11, s11, s32
    s_mov_b32 s13, s12
    v_readlane_b32 s12, v5, s9
    v_readlane_b32 s3, v10, s9
    s_cmp_lt_u32 s9, 64
    s_cselect_b32 s12, s12, s3
    s_add_u32 s9, s9, 1
    s_cmp_le_u32 s9, s8
    s_cbranch_scc1 L_ld4
    s_branch L_ldone
L_pre2:
    v_add_u32 v9, 64, v251
    v_add_u32 v248, s7, v9
    v_mov_b32 v6, 0
    v_mov_b32 v7, s68
    v_mov_b32 v8, 0
    v_cmpx_le_u32 vcc, s77, v248
    v_mov_b32 v7, s69
    v_mov_b32 v8, s77
    v_mov_b32 v6, 2048
    v_cmpx_le_u32 vcc, s78, v248
    v_mov_b32 v7, s70
    v_mov_b32 v8, s78
    v_mov_b32 v6, 4096
    v_cmpx_le_u32 vcc, s79, v248
    v_mov_b32 v7, s71
    v_mov_b32 v8, s79
    v_mov_b32 v6, 6144
    v_cmpx_le_u32 vcc, s80, v248
    v_mov_b32 v7, s72
    v_mov_b32 v8, s80
    v_mov_b32 v6, 8192
    v_cmpx_le_u32 vcc, s81, v248
    v_mov_b32 v7, s73
    v_mov_b32 v8, s81
    v_mov_b32 v6, 10240
    v_cmpx_le_u32 vcc, s82, v248
    v_mov_b32 v7, s74
    v_mov_b32 v8, s82
    v_mov_b32 v6, 12288
    v_cmpx_le_u32 vcc, s83, v248
    v_mov_b32 v7, s75
    v_mov_b32 v8, s83
    v_mov_b32 v6, 14336
    s_mov_b64 exec, -1
    v_sub_u32 v248, v248, v8
    v_lshl_add_u32 v248, v248, 1, s15
    v_lshl_add_u32 v249, v248, 2, v6
    v_min_u32 v249, 16380, v249
    v_add_u32 v249, 98304, v249
    ds_read_b32 v10, v249
    v_lshlrev_b32 v248, 4, v248
    v_cmp_lt_u32 s[94:95], v248, v7
    v_cmp_gt_u32 vcc, s8, v9
    v_mov_b32 v248, 0x80000000
    s_and_b64 s[94:95], s[94:95], vcc
    s_waitcnt lgkmcnt(0)
    v_lshlrev_b32 v10, 15, v10
    v_cndmask_b32 v10, v248, v10, s[94:95]
    s_add_u32 s8, s8, 3
    s_mov_b32 s13, s12
    v_readlane_b32 s12, v5, s9
    v_readlane_b32 s3, v10, s9
    s_cmp_lt_u32 s9, 64
    s_cselect_b32 s12, s12, s3
    s_add_u32 s9, s9, 1
L_ld2:
    s_waitcnt vmcnt(4)
    s_barrier
    s_mov_b32 m0, s10
    s_add_u32 s10, s10, 8192
    buffer_load_dwordx4 v1, s[40:43], s12 offen nt lds
    buffer_load_dwordx4 v2, s[40:43], s12 offen offset:1024 nt lds
    s_mov_b32 m0, s11
    s_add_u32 s11, s11, 8192
    buffer_load_dwordx4 v3, s[44:47], s13 offen nt lds
    buffer_load_dwordx4 v4, s[44:47], s13 offen offset:1024 nt lds
    s_cmp_ge_u32 s10, 49152
    s_cselect_b32 s32, 49152, 0
    s_sub_u32 s10, s10, s32
    s_cmp_ge_u32 s11, 98304
    s_cselect_b32 s32, 49152, 0
    s_sub_u32 s11, s11, s32
    s_mov_b32 s13, s12
    v_readlane_b32 s12, v5, s9
    v_readlane_b32 s3, v10, s9
    s_cmp_lt_u32 s9, 64
    s_cselect_b32 s12, s12, s3
    s_add_u32 s9, s9, 1
    s_cmp_le_u32 s9, s8
    s_cbranch_scc1 L_ld2
    s_branch L_ldone
L_ldone:
    s_mov_b32 s48, s30
    s_and_b32 s49, s31, 0xffff
    s_mov_b32 s50, 0x2000000
    s_mov_b32 s51, 0x20000
    s_mov_b32 s36, s28
    s_and_b32 s37, s29, 0xffff
    s_mov_b32 s38, 0x100
    s_mov_b32 s39, 0x20000
    s_mov_b32 s32, 0
    s_mov_b32 s10, 0
    s_mov_b32 s11, s77
    s_cmp_le_u32 s77, s7
    s_cselect_b32 s32, 1, s32
    s_cselect_b32 s10, s77, s10
    s_cselect_b32 s11, s78, s11
    s_cmp_le_u32 s78, s7
    s_cselect_b32 s32, 2, s32
    s_cselect_b32 s10, s78, s10
    s_cselect_b32 s11, s79, s11
    s_cmp_le_u32 s79, s7
    s_cselect_b32 s32, 3, s32
    s_cselect_b32 s10, s79, s10
    s_cselect_b32 s11, s80, s11
    s_cmp_le_u32 s80, s7
    s_cselect_b32 s32, 4, s32
    s_cselect_b32 s10, s80, s10
    s_cselect_b32 s11, s81, s11
    s_cmp_le_u32 s81, s7
    s_cselect_b32 s32, 5, s32
    s_cselect_b32 s10, s81, s10
    s_cselect_b32 s11, s82, s11
    s_cmp_le_u32 s82, s7
    s_cselect_b32 s32, 6, s32
    s_cselect_b32 s10, s82, s10
    s_cselect_b32 s11, s83, s11
    s_cmp_le_u32 s83, s7
    s_cselect_b32 s32, 7, s32
    s_cselect_b32 s10, s83, s10
    s_cselect_b32 s11, s84, s11
    s_cmp_lt_u32 s10, s7
    s_cbranch_scc0 L_lend
    s_add_u32 s7, s7, s8
    s_sub_u32 s7, s7, s14
    s_sub_u32 s7, s7, 1
    s_cmp_lt_u32 s11, s7
    s_cbranch_scc0 L_lend
    s_mul_i32 s3, s6, 8704
    s_add_u32 s3, s3, 98304
    v_lshl_add_u32 v1, v251, 4, s3
    v_lshl_add_u32 v2, v251, 3, s3
    ds_read_b128 v[32:35], v1 offset:0
    ds_read_b128 v[36:39], v1 offset:1024
    ds_read_b128 v[40:43], v1 offset:2048
    ds_read_b128 v[44:47], v1 offset:3072
    ds_read_b128 v[48:51], v1 offset:4096
    ds_read_b128 v[52:55], v1 offset:5120
    ds_read_b128 v[56:59], v1 offset:6144
    ds_read_b128 v[60:63], v1 offset:7168
    ds_read_b64 v[30:31], v2 offset:8192
    s_lshl_b32 s12, s4, 5
    buffer_load_dword v3, off, s[36:39], s12 sc1
    s_mul_i32 s3, s4, 44
    s_add_u32 s32, s32, s3
    s_add_u32 s32, s32, s5
    s_lshl_b32 s32, s32, 2
    s_add_u32 s32, s32, s6
    s_lshl_b32 s13, s32, 6
    s_add_u32 s13, s13, 14680064
    s_lshl_b32 s33, s32, 9
    s_add_u32 s33, s33, 11534336
    s_lshl_b32 s32, s32, 13
    s_add_u32 s10, s32, 4096
    v_lshlrev_b32 v1, 4, v251
    v_lshlrev_b32 v2, 3, v251
    s_waitcnt lgkmcnt(8)
    buffer_store_dwordx4 v[32:35], v1, s[48:51], s32 offen offset:0 sc1
    s_waitcnt lgkmcnt(7)
    buffer_store_dwordx4 v[36:39], v1, s[48:51], s32 offen offset:1024 sc1
    s_waitcnt lgkmcnt(6)
    buffer_store_dwordx4 v[40:43], v1, s[48:51], s32 offen offset:2048 sc1
    s_waitcnt lgkmcnt(5)
    buffer_store_dwordx4 v[44:47], v1, s[48:51], s32 offen offset:3072 sc1
    s_waitcnt lgkmcnt(4)
    buffer_store_dwordx4 v[48:51], v1, s[48:51], s10 offen offset:0 sc1
    s_waitcnt lgkmcnt(3)
    buffer_store_dwordx4 v[52:55], v1, s[48:51], s10 offen offset:1024 sc1
    s_waitcnt lgkmcnt(2)
    buffer_store_dwordx4 v[56:59], v1, s[48:51], s10 offen offset:2048 sc1
    s_waitcnt lgkmcnt(1)
    buffer_store_dwordx4 v[60:63], v1, s[48:51], s10 offen offset:3072 sc1
    s_waitcnt lgkmcnt(0)
    buffer_store_dwordx2 v[30:31], v2, s[48:51], s33 offen sc1
    s_mov_b32 s11, 0x100000
    v_mov_b32 v4, 1
L_lgo:
    s_waitcnt vmcnt(0)
    v_readfirstlane_b32 s3, v3
    s_cmp_lg_u32 s3, 0
    s_cbranch_scc1 L_lgo_ok
    buffer_load_dword v3, off, s[36:39], s12 sc1
    s_sub_u32 s11, s11, 1
    s_cbranch_scc0 L_lgo
L_lgo_ok:
    s_mov_b64 exec, 1
    buffer_store_dword v4, off, s[48:51], s13 sc1
    s_mov_b64 exec, -1
L_lend:
L_lidle:
    s_waitcnt vmcnt(0)
    s_endpgm
.section .rodata,"a"
.p2align 6
.amdhsa_kernel standalone__paged_block_table_kv_pagedattention__sampling_kernel
  .amdhsa_next_free_vgpr 256
  .amdhsa_next_free_sgpr 102
  .amdhsa_accum_offset 256
  .amdhsa_group_segment_fixed_size 0
  .amdhsa_kernarg_size 64
  .amdhsa_user_sgpr_count 2
  .amdhsa_user_sgpr_kernarg_segment_ptr 1
  .amdhsa_system_sgpr_workgroup_id_x 1
.end_amdhsa_kernel
```
